```python
import torch

def _softmax(x, axis=-1):
    return torch.softmax(x, dim=axis)

def _gelu(x):
    return torch.nn.functional.gelu(x, approximate='tanh')

def _silu(x):
    return torch.nn.functional.silu(x)

def _sigmoid(x):
    return torch.sigmoid(x)

def _layernorm(x, axis=-1, eps=1e-05):
    m = x.mean(dim=axis, keepdim=True)
    v = x.var(dim=axis, keepdim=True, unbiased=False)
    return (x - m) / torch.sqrt(v + eps)

def _scatter_add(tgt, idx, src, axis=0):
    return tgt.clone().index_add_(axis, idx, src)

def _segment_sum(src, seg, n):
    out = torch.zeros((n,) + src.shape[1:], dtype=src.dtype)
    return out.index_add_(0, seg, src)

def _pad(x, pw):
    flat = tuple((v for pair in reversed(pw) for v in pair))
    return torch.nn.functional.pad(x, flat)
kernel_name = 'standalone__dilated_atrous__vision'

def setup_inputs():

    _w = lambda a: (lambda t: t.to(torch.bfloat16) if t.is_floating_point() else t)(torch.as_tensor(a))
    H = W = 224
    C = 96
    k = 3
    return {'x': _w((lambda *s: torch.randn(*s, dtype=torch.bfloat16) * 0.05)(1, H, W, C)), 'w': _w((lambda *s: torch.randn(*s, dtype=torch.bfloat16) * 0.05)(k, k, C, C) * (1.0 / (k * C ** 0.5)))}

def reference(x, w):
    B, H, W, C = x.shape
    k = 3
    rate = 2
    pad = (k - 1) * rate // 2
    xp = _pad(x, ((0, 0), (pad, pad), (pad, pad), (0, 0)))
    out = torch.zeros_like(x)
    for i in range(k):
        for j in range(k):
            tap = xp[:, i * rate:i * rate + H, j * rate:j * rate + W, :].clone()
            out = out + torch.einsum('bhwc,co->bhwo', tap, w[i, j])
    return out
```

```asm
; @launch grid=(224,1,1) block=(256,1,1) lds=158464
.amdgcn_target "amdgcn-amd-amdhsa--gfx950"
.text
.globl standalone__dilated_atrous__vision_kernel
.p2align 8
.type standalone__dilated_atrous__vision_kernel,@function
standalone__dilated_atrous__vision_kernel:
    s_cmp_ge_u32 s2, 224
    s_cbranch_scc1 L_end
    s_load_dwordx4 s[4:7], s[0:1], 0
    s_load_dwordx2 s[8:9], s[0:1], 16
    s_and_b32 s3, s2, 7
    s_lshr_b32 s10, s2, 3
    s_mul_i32 s3, s3, 28
    s_add_u32 s3, s3, s10
    s_mul_i32 s10, s3, 4682
    s_lshr_b32 s10, s10, 16
    s_mul_i32 s11, s10, 14
    s_sub_u32 s11, s3, s11
    s_mul_i32 s25, s10, 14
    s_lshl_b32 s26, s11, 4
    v_lshrrev_b32 v1, 6, v0
    v_and_b32 v0, 63, v0
    v_readfirstlane_b32 s24, v1
    v_mul_u32_u24 v2, 4682, v0
    v_lshrrev_b32 v2, 16, v2
    v_mul_u32_u24 v3, 14, v2
    v_sub_u32 v3, v0, v3
    v_mul_u32_u24 v4, 192, v2
    v_lshl_add_u32 v4, v3, 4, v4
    s_cmp_eq_u32 s26, 0
    s_cselect_b32 s27, -384, 0
    s_cselect_b32 s28, 0, 2
    s_cselect_b64 s[30:31], -1, 0
    s_sub_u32 s28, s26, s28
    s_cmp_eq_u32 s26, 208
    s_cselect_b64 s[32:33], -1, 0
    v_add_u32 v4, s27, v4
    v_mov_b32 v5, 0x40000000
    v_cmp_gt_u32 vcc, 2, v2
    s_and_b64 s[30:31], s[30:31], vcc
    v_cmp_le_u32 vcc, 2, v2
    s_and_b64 s[32:33], s[32:33], vcc
    v_cndmask_b32 v10, v4, v5, s[30:31]
    v_add_u32 v11, 768, v4
    v_add_u32 v12, 1536, v4
    v_add_u32 v13, 2304, v4
    v_add_u32 v14, 3072, v4
    v_cndmask_b32 v14, v14, v5, s[32:33]
    s_mul_i32 s29, s24, 5
    s_add_u32 s29, s29, 0
    s_min_u32 s29, s29, 18
    s_lshl_b32 s29, s29, 6
    v_add_u32 v8, s29, v0
    v_mul_u32_u24 v9, 669, v8
    v_lshrrev_b32 v9, 16, v9
    v_mul_u32_u24 v15, 98, v9
    v_sub_u32 v15, v8, v15
    v_min_u32 v15, 95, v15
    v_mul_u32_u24 v9, 1536, v9
    v_lshl_add_u32 v244, v15, 4, v9
    s_mul_i32 s29, s24, 5
    s_add_u32 s29, s29, 1
    s_min_u32 s29, s29, 18
    s_lshl_b32 s29, s29, 6
    v_add_u32 v8, s29, v0
    v_mul_u32_u24 v9, 669, v8
    v_lshrrev_b32 v9, 16, v9
    v_mul_u32_u24 v15, 98, v9
    v_sub_u32 v15, v8, v15
    v_min_u32 v15, 95, v15
    v_mul_u32_u24 v9, 1536, v9
    v_lshl_add_u32 v245, v15, 4, v9
    s_mul_i32 s29, s24, 5
    s_add_u32 s29, s29, 2
    s_min_u32 s29, s29, 18
    s_lshl_b32 s29, s29, 6
    v_add_u32 v8, s29, v0
    v_mul_u32_u24 v9, 669, v8
    v_lshrrev_b32 v9, 16, v9
    v_mul_u32_u24 v15, 98, v9
    v_sub_u32 v15, v8, v15
    v_min_u32 v15, 95, v15
    v_mul_u32_u24 v9, 1536, v9
    v_lshl_add_u32 v246, v15, 4, v9
    s_mul_i32 s29, s24, 5
    s_add_u32 s29, s29, 3
    s_min_u32 s29, s29, 18
    s_lshl_b32 s29, s29, 6
    v_add_u32 v8, s29, v0
    v_mul_u32_u24 v9, 669, v8
    v_lshrrev_b32 v9, 16, v9
    v_mul_u32_u24 v15, 98, v9
    v_sub_u32 v15, v8, v15
    v_min_u32 v15, 95, v15
    v_mul_u32_u24 v9, 1536, v9
    v_lshl_add_u32 v247, v15, 4, v9
    s_mul_i32 s29, s24, 5
    s_add_u32 s29, s29, 4
    s_min_u32 s29, s29, 18
    s_lshl_b32 s29, s29, 6
    v_add_u32 v8, s29, v0
    v_mul_u32_u24 v9, 669, v8
    v_lshrrev_b32 v9, 16, v9
    v_mul_u32_u24 v15, 98, v9
    v_sub_u32 v15, v8, v15
    v_min_u32 v15, 95, v15
    v_mul_u32_u24 v9, 1536, v9
    v_lshl_add_u32 v248, v15, 4, v9
    s_mov_b32 s34, 0xf3ffcfff
    s_mov_b32 s35, 0x003ffcff
    s_mov_b32 s36, -1
    s_mov_b32 s37, 0xffff
    s_mul_i32 s42, s24, 5120
    s_add_u32 s76, s42, 4096
    s_min_u32 s76, s76, 18432
    s_mul_i32 s43, s24, 4480
    s_waitcnt lgkmcnt(0)
    s_mov_b32 s16, s6
    s_and_b32 s17, s7, 0xffff
    s_mov_b32 s18, 165888
    s_mov_b32 s19, 0x00020000
    s_mov_b32 s12, s4
    s_and_b32 s13, s5, 0xffff
    s_mov_b32 s14, 9633792
    s_mov_b32 s15, 0x00020000
    s_lshr_b32 s45, s2, 3
    s_lshl_b32 s45, s45, 2
    s_add_u32 s45, s45, s24
    s_lshl_b32 s45, s45, 10
    v_lshlrev_b32 v5, 4, v0
    v_add_u32 v5, s45, v5
    buffer_load_dwordx4 v[176:179], v5, s[16:19], 0 offen
    v_add_u32 v5, 114688, v5
    buffer_load_dwordx4 v[180:183], v5, s[16:19], 0 offen
    s_mov_b32 s44, 0
    s_add_u32 m0, s42, 80640
    s_nop 0
    buffer_load_dwordx4 v244, s[16:19], s44 offen lds
    s_add_u32 m0, s42, 81664
    s_nop 0
    buffer_load_dwordx4 v245, s[16:19], s44 offen lds
    s_add_u32 m0, s42, 82688
    s_nop 0
    buffer_load_dwordx4 v246, s[16:19], s44 offen lds
    s_add_u32 m0, s42, 83712
    s_nop 0
    buffer_load_dwordx4 v247, s[16:19], s44 offen lds
    s_add_u32 m0, s76, 80640
    s_nop 0
    buffer_load_dwordx4 v248, s[16:19], s44 offen lds
    s_mov_b64 exec, s[34:35]
    s_add_u32 s45, s25, s24
    s_add_u32 s45, s45, -2
    s_mul_i32 s46, s45, 224
    s_add_u32 s46, s46, s28
    s_mul_i32 s46, s46, 192
    s_cmp_lt_u32 s45, 224
    s_cselect_b32 s46, s46, 0x40000000
    s_add_u32 m0, s43, 0
    v_add_u32 v5, s46, v10
    buffer_load_dwordx4 v5, s[12:15], 0 offen lds
    s_add_u32 m0, s43, 896
    v_add_u32 v5, s46, v11
    buffer_load_dwordx4 v5, s[12:15], 0 offen lds
    s_add_u32 m0, s43, 1792
    v_add_u32 v5, s46, v12
    buffer_load_dwordx4 v5, s[12:15], 0 offen lds
    s_add_u32 m0, s43, 2688
    v_add_u32 v5, s46, v13
    buffer_load_dwordx4 v5, s[12:15], 0 offen lds
    s_add_u32 m0, s43, 3584
    v_add_u32 v5, s46, v14
    buffer_load_dwordx4 v5, s[12:15], 0 offen lds
    s_add_u32 s45, s25, s24
    s_add_u32 s45, s45, 2
    s_mul_i32 s46, s45, 224
    s_add_u32 s46, s46, s28
    s_mul_i32 s46, s46, 192
    s_cmp_lt_u32 s45, 224
    s_cselect_b32 s46, s46, 0x40000000
    s_add_u32 m0, s43, 17920
    v_add_u32 v5, s46, v10
    buffer_load_dwordx4 v5, s[12:15], 0 offen lds
    s_add_u32 m0, s43, 18816
    v_add_u32 v5, s46, v11
    buffer_load_dwordx4 v5, s[12:15], 0 offen lds
    s_add_u32 m0, s43, 19712
    v_add_u32 v5, s46, v12
    buffer_load_dwordx4 v5, s[12:15], 0 offen lds
    s_add_u32 m0, s43, 20608
    v_add_u32 v5, s46, v13
    buffer_load_dwordx4 v5, s[12:15], 0 offen lds
    s_add_u32 m0, s43, 21504
    v_add_u32 v5, s46, v14
    buffer_load_dwordx4 v5, s[12:15], 0 offen lds
    s_add_u32 s45, s25, s24
    s_add_u32 s45, s45, 6
    s_mul_i32 s46, s45, 224
    s_add_u32 s46, s46, s28
    s_mul_i32 s46, s46, 192
    s_cmp_lt_u32 s45, 224
    s_cselect_b32 s46, s46, 0x40000000
    s_add_u32 m0, s43, 35840
    v_add_u32 v5, s46, v10
    buffer_load_dwordx4 v5, s[12:15], 0 offen lds
    s_add_u32 m0, s43, 36736
    v_add_u32 v5, s46, v11
    buffer_load_dwordx4 v5, s[12:15], 0 offen lds
    s_add_u32 m0, s43, 37632
    v_add_u32 v5, s46, v12
    buffer_load_dwordx4 v5, s[12:15], 0 offen lds
    s_add_u32 m0, s43, 38528
    v_add_u32 v5, s46, v13
    buffer_load_dwordx4 v5, s[12:15], 0 offen lds
    s_add_u32 m0, s43, 39424
    v_add_u32 v5, s46, v14
    buffer_load_dwordx4 v5, s[12:15], 0 offen lds
    s_mov_b64 exec, -1
    s_mov_b32 s44, 18432
    s_add_u32 m0, s42, 100096
    s_nop 0
    buffer_load_dwordx4 v244, s[16:19], s44 offen lds
    s_add_u32 m0, s42, 101120
    s_nop 0
    buffer_load_dwordx4 v245, s[16:19], s44 offen lds
    s_add_u32 m0, s42, 102144
    s_nop 0
    buffer_load_dwordx4 v246, s[16:19], s44 offen lds
    s_add_u32 m0, s42, 103168
    s_nop 0
    buffer_load_dwordx4 v247, s[16:19], s44 offen lds
    s_add_u32 m0, s76, 100096
    s_nop 0
    buffer_load_dwordx4 v248, s[16:19], s44 offen lds
    s_mov_b64 exec, -1
    s_add_u32 s45, s25, s24
    s_add_u32 s45, s45, 10
    s_mul_i32 s74, s45, 224
    s_add_u32 s74, s74, s28
    s_mul_i32 s74, s74, 192
    s_cmp_lt_u32 s45, 224
    s_cselect_b32 s74, s74, 0x40000000
    s_add_u32 s45, s25, s24
    s_add_u32 s45, s45, 14
    s_mul_i32 s75, s45, 224
    s_add_u32 s75, s75, s28
    s_mul_i32 s75, s75, 192
    s_cmp_lt_u32 s45, 224
    s_cselect_b32 s75, s75, 0x40000000
    s_lshr_b32 s38, s24, 1
    s_and_b32 s39, s24, 1
    v_and_b32 v6, 15, v0
    v_lshrrev_b32 v7, 4, v0
    s_mul_i32 s40, s39, 4480
    v_mul_u32_u24 v16, 224, v6
    v_lshl_add_u32 v16, v7, 4, v16
    v_add_u32 v16, s40, v16
    v_add_u32 v17, 44800, v16
    v_lshrrev_b32 v8, 2, v6
    v_and_b32 v9, 3, v6
    v_mul_u32_u24 v18, 1568, v7
    v_mul_u32_u24 v8, 192, v8
    v_add_u32 v18, v18, v8
    v_lshl_add_u32 v18, v9, 3, v18
    s_mul_i32 s41, s38, 96
    s_add_u32 s41, s41, 80640
    v_add_u32 v18, s41, v18
    v_add_u32 v19, 38912, v18
    v_mul_u32_u24 v22, 192, v6
    s_mul_i32 s41, s38, 96
    v_add_u32 v22, s41, v22
    v_lshrrev_b32 v8, 1, v7
    v_and_b32 v9, 1, v7
    v_lshl_add_u32 v20, v8, 4, v22
    v_lshl_add_u32 v20, v9, 5, v20
    v_lshl_add_u32 v21, v7, 3, v22
    v_add_u32 v21, 64, v21
    s_add_u32 s47, s39, s25
    s_mul_i32 s47, s47, 224
    s_add_u32 s47, s47, s26
    s_mul_i32 s47, s47, 192
    s_mov_b32 s20, s8
    s_and_b32 s21, s9, 0xffff
    s_mov_b32 s22, 9633792
    s_mov_b32 s23, 0x00020000
    s_waitcnt vmcnt(5)
    s_barrier
    ds_read_b64_tr_b16 a[0:1], v18 offset:0
    ds_read_b64_tr_b16 a[2:3], v18 offset:768
    ds_read_b64_tr_b16 a[4:5], v18 offset:32
    ds_read_b64_tr_b16 a[6:7], v18 offset:800
    ds_read_b64_tr_b16 a[8:9], v18 offset:64
    ds_read_b64_tr_b16 a[10:11], v18 offset:832
    ds_read_b128 v[108:111], v16 offset:0
    ds_read_b128 v[112:115], v16 offset:8960
    ds_read_b128 v[116:119], v16 offset:17920
    ds_read_b128 v[120:123], v16 offset:26880
    ds_read_b128 v[124:127], v16 offset:35840
    s_waitcnt lgkmcnt(2)
    v_mfma_f32_16x16x32_bf16 v[24:27], a[0:3], v[108:111], 0
    ds_read_b64_tr_b16 a[12:13], v18 offset:6272
    v_mfma_f32_16x16x32_bf16 v[28:31], a[4:7], v[108:111], 0
    ds_read_b64_tr_b16 a[14:15], v18 offset:7040
    v_mfma_f32_16x16x32_bf16 v[32:35], a[8:11], v[108:111], 0
    ds_read_b64_tr_b16 a[16:17], v18 offset:6304
    v_mfma_f32_16x16x32_bf16 v[36:39], a[0:3], v[112:115], 0
    ds_read_b64_tr_b16 a[18:19], v18 offset:7072
    v_mfma_f32_16x16x32_bf16 v[40:43], a[4:7], v[112:115], 0
    s_mov_b32 s44, 36864
    s_add_u32 m0, s42, 119552
    s_nop 0
    buffer_load_dwordx4 v244, s[16:19], s44 offen lds
    v_mfma_f32_16x16x32_bf16 v[44:47], a[8:11], v[112:115], 0
    ds_read_b64_tr_b16 a[20:21], v18 offset:6336
    v_mfma_f32_16x16x32_bf16 v[48:51], a[0:3], v[116:119], 0
    ds_read_b64_tr_b16 a[22:23], v18 offset:7104
    v_mfma_f32_16x16x32_bf16 v[52:55], a[4:7], v[116:119], 0
    ds_read_b128 v[128:131], v16 offset:64
    v_mfma_f32_16x16x32_bf16 v[56:59], a[8:11], v[116:119], 0
    ds_read_b128 v[132:135], v16 offset:9024
    s_waitcnt lgkmcnt(8)
    v_mfma_f32_16x16x32_bf16 v[60:63], a[0:3], v[120:123], 0
    ds_read_b128 v[136:139], v16 offset:17984
    v_mfma_f32_16x16x32_bf16 v[64:67], a[4:7], v[120:123], 0
    ds_read_b128 v[140:143], v16 offset:26944
    v_mfma_f32_16x16x32_bf16 v[68:71], a[8:11], v[120:123], 0
    ds_read_b128 v[144:147], v16 offset:35904
    v_mfma_f32_16x16x32_bf16 v[72:75], a[0:3], v[124:127], 0
    v_mfma_f32_16x16x32_bf16 v[76:79], a[4:7], v[124:127], 0
    s_add_u32 m0, s42, 120576
    s_nop 0
    buffer_load_dwordx4 v245, s[16:19], s44 offen lds
    v_mfma_f32_16x16x32_bf16 v[80:83], a[8:11], v[124:127], 0
    s_waitcnt lgkmcnt(2)
    v_mfma_f32_16x16x32_bf16 v[24:27], a[12:15], v[128:131], v[24:27]
    ds_read_b64_tr_b16 a[24:25], v18 offset:12544
    v_mfma_f32_16x16x32_bf16 v[28:31], a[16:19], v[128:131], v[28:31]
    ds_read_b64_tr_b16 a[26:27], v18 offset:13312
    v_mfma_f32_16x16x32_bf16 v[32:35], a[20:23], v[128:131], v[32:35]
    ds_read_b64_tr_b16 a[28:29], v18 offset:12576
    v_mfma_f32_16x16x32_bf16 v[36:39], a[12:15], v[132:135], v[36:39]
    ds_read_b64_tr_b16 a[30:31], v18 offset:13344
    v_mfma_f32_16x16x32_bf16 v[40:43], a[16:19], v[132:135], v[40:43]
    ds_read_b64_tr_b16 a[32:33], v18 offset:12608
    v_mfma_f32_16x16x32_bf16 v[44:47], a[20:23], v[132:135], v[44:47]
    ds_read_b64_tr_b16 a[34:35], v18 offset:13376
    v_mfma_f32_16x16x32_bf16 v[48:51], a[12:15], v[136:139], v[48:51]
    ds_read_b128 v[108:111], v16 offset:128
    v_mfma_f32_16x16x32_bf16 v[52:55], a[16:19], v[136:139], v[52:55]
    s_add_u32 m0, s42, 121600
    s_nop 0
    buffer_load_dwordx4 v246, s[16:19], s44 offen lds
    v_mfma_f32_16x16x32_bf16 v[56:59], a[20:23], v[136:139], v[56:59]
    ds_read_b128 v[112:115], v16 offset:9088
    s_waitcnt lgkmcnt(8)
    v_mfma_f32_16x16x32_bf16 v[60:63], a[12:15], v[140:143], v[60:63]
    ds_read_b128 v[116:119], v16 offset:18048
    v_mfma_f32_16x16x32_bf16 v[64:67], a[16:19], v[140:143], v[64:67]
    ds_read_b128 v[120:123], v16 offset:27008
    v_mfma_f32_16x16x32_bf16 v[68:71], a[20:23], v[140:143], v[68:71]
    ds_read_b128 v[124:127], v16 offset:35968
    v_mfma_f32_16x16x32_bf16 v[72:75], a[12:15], v[144:147], v[72:75]
    v_mfma_f32_16x16x32_bf16 v[76:79], a[16:19], v[144:147], v[76:79]
    v_mfma_f32_16x16x32_bf16 v[80:83], a[20:23], v[144:147], v[80:83]
    s_waitcnt lgkmcnt(5)
    s_waitcnt vmcnt(3)
    s_barrier
    s_waitcnt lgkmcnt(2)
    v_mfma_f32_16x16x32_bf16 v[24:27], a[24:27], v[108:111], v[24:27]
    ds_read_b64_tr_b16 a[36:37], v18 offset:19456
    v_mfma_f32_16x16x32_bf16 v[28:31], a[28:31], v[108:111], v[28:31]
    s_add_u32 m0, s42, 122624
    s_nop 0
    buffer_load_dwordx4 v247, s[16:19], s44 offen lds
    v_mfma_f32_16x16x32_bf16 v[32:35], a[32:35], v[108:111], v[32:35]
    ds_read_b64_tr_b16 a[38:39], v18 offset:20224
    v_mfma_f32_16x16x32_bf16 v[36:39], a[24:27], v[112:115], v[36:39]
    ds_read_b64_tr_b16 a[40:41], v18 offset:19488
    v_mfma_f32_16x16x32_bf16 v[40:43], a[28:31], v[112:115], v[40:43]
    ds_read_b64_tr_b16 a[42:43], v18 offset:20256
    v_mfma_f32_16x16x32_bf16 v[44:47], a[32:35], v[112:115], v[44:47]
    ds_read_b64_tr_b16 a[44:45], v18 offset:19520
    v_mfma_f32_16x16x32_bf16 v[48:51], a[24:27], v[116:119], v[48:51]
    ds_read_b64_tr_b16 a[46:47], v18 offset:20288
    v_mfma_f32_16x16x32_bf16 v[52:55], a[28:31], v[116:119], v[52:55]
    ds_read_b128 v[128:131], v16 offset:448
    v_mfma_f32_16x16x32_bf16 v[56:59], a[32:35], v[116:119], v[56:59]
    ds_read_b128 v[132:135], v16 offset:9408
    s_waitcnt lgkmcnt(8)
    v_mfma_f32_16x16x32_bf16 v[60:63], a[24:27], v[120:123], v[60:63]
    ds_read_b128 v[136:139], v16 offset:18368
    v_mfma_f32_16x16x32_bf16 v[64:67], a[28:31], v[120:123], v[64:67]
    s_add_u32 m0, s76, 119552
    s_nop 0
    buffer_load_dwordx4 v248, s[16:19], s44 offen lds
    v_mfma_f32_16x16x32_bf16 v[68:71], a[32:35], v[120:123], v[68:71]
    ds_read_b128 v[140:143], v16 offset:27328
    v_mfma_f32_16x16x32_bf16 v[72:75], a[24:27], v[124:127], v[72:75]
    ds_read_b128 v[144:147], v16 offset:36288
    v_mfma_f32_16x16x32_bf16 v[76:79], a[28:31], v[124:127], v[76:79]
    v_mfma_f32_16x16x32_bf16 v[80:83], a[32:35], v[124:127], v[80:83]
    s_waitcnt lgkmcnt(2)
    v_mfma_f32_16x16x32_bf16 v[24:27], a[36:39], v[128:131], v[24:27]
    ds_read_b64_tr_b16 a[48:49], v18 offset:25728
    v_mfma_f32_16x16x32_bf16 v[28:31], a[40:43], v[128:131], v[28:31]
    ds_read_b64_tr_b16 a[50:51], v18 offset:26496
    v_mfma_f32_16x16x32_bf16 v[32:35], a[44:47], v[128:131], v[32:35]
    ds_read_b64_tr_b16 a[52:53], v18 offset:25760
    v_mfma_f32_16x16x32_bf16 v[36:39], a[36:39], v[132:135], v[36:39]
    s_mov_b32 s44, 55296
    s_add_u32 m0, s42, 139008
    s_nop 0
    buffer_load_dwordx4 v244, s[16:19], s44 offen lds
    v_mfma_f32_16x16x32_bf16 v[40:43], a[40:43], v[132:135], v[40:43]
    ds_read_b64_tr_b16 a[54:55], v18 offset:26528
    v_mfma_f32_16x16x32_bf16 v[44:47], a[44:47], v[132:135], v[44:47]
    ds_read_b64_tr_b16 a[56:57], v18 offset:25792
    v_mfma_f32_16x16x32_bf16 v[48:51], a[36:39], v[136:139], v[48:51]
    ds_read_b64_tr_b16 a[58:59], v18 offset:26560
    v_mfma_f32_16x16x32_bf16 v[52:55], a[40:43], v[136:139], v[52:55]
    ds_read_b128 v[108:111], v16 offset:512
    v_mfma_f32_16x16x32_bf16 v[56:59], a[44:47], v[136:139], v[56:59]
    ds_read_b128 v[112:115], v16 offset:9472
    s_waitcnt lgkmcnt(8)
    v_mfma_f32_16x16x32_bf16 v[60:63], a[36:39], v[140:143], v[60:63]
    s_add_u32 m0, s42, 140032
    s_nop 0
    buffer_load_dwordx4 v245, s[16:19], s44 offen lds
    v_mfma_f32_16x16x32_bf16 v[64:67], a[40:43], v[140:143], v[64:67]
    ds_read_b128 v[116:119], v16 offset:18432
    v_mfma_f32_16x16x32_bf16 v[68:71], a[44:47], v[140:143], v[68:71]
    ds_read_b128 v[120:123], v16 offset:27392
    v_mfma_f32_16x16x32_bf16 v[72:75], a[36:39], v[144:147], v[72:75]
    ds_read_b128 v[124:127], v16 offset:36352
    v_mfma_f32_16x16x32_bf16 v[76:79], a[40:43], v[144:147], v[76:79]
    v_mfma_f32_16x16x32_bf16 v[80:83], a[44:47], v[144:147], v[80:83]
    s_waitcnt lgkmcnt(2)
    v_mfma_f32_16x16x32_bf16 v[24:27], a[48:51], v[108:111], v[24:27]
    ds_read_b64_tr_b16 a[60:61], v18 offset:32000
    v_mfma_f32_16x16x32_bf16 v[28:31], a[52:55], v[108:111], v[28:31]
    s_add_u32 m0, s42, 141056
    s_nop 0
    buffer_load_dwordx4 v246, s[16:19], s44 offen lds
    v_mfma_f32_16x16x32_bf16 v[32:35], a[56:59], v[108:111], v[32:35]
    ds_read_b64_tr_b16 a[62:63], v18 offset:32768
    v_mfma_f32_16x16x32_bf16 v[36:39], a[48:51], v[112:115], v[36:39]
    ds_read_b64_tr_b16 a[64:65], v18 offset:32032
    v_mfma_f32_16x16x32_bf16 v[40:43], a[52:55], v[112:115], v[40:43]
    ds_read_b64_tr_b16 a[66:67], v18 offset:32800
    v_mfma_f32_16x16x32_bf16 v[44:47], a[56:59], v[112:115], v[44:47]
    ds_read_b64_tr_b16 a[68:69], v18 offset:32064
    v_mfma_f32_16x16x32_bf16 v[48:51], a[48:51], v[116:119], v[48:51]
    ds_read_b64_tr_b16 a[70:71], v18 offset:32832
    v_mfma_f32_16x16x32_bf16 v[52:55], a[52:55], v[116:119], v[52:55]
    s_add_u32 m0, s42, 142080
    s_nop 0
    buffer_load_dwordx4 v247, s[16:19], s44 offen lds
    v_mfma_f32_16x16x32_bf16 v[56:59], a[56:59], v[116:119], v[56:59]
    ds_read_b128 v[128:131], v16 offset:576
    s_waitcnt lgkmcnt(7)
    v_mfma_f32_16x16x32_bf16 v[60:63], a[48:51], v[120:123], v[60:63]
    ds_read_b128 v[132:135], v16 offset:9536
    v_mfma_f32_16x16x32_bf16 v[64:67], a[52:55], v[120:123], v[64:67]
    ds_read_b128 v[136:139], v16 offset:18496
    v_mfma_f32_16x16x32_bf16 v[68:71], a[56:59], v[120:123], v[68:71]
    ds_read_b128 v[140:143], v16 offset:27456
    v_mfma_f32_16x16x32_bf16 v[72:75], a[48:51], v[124:127], v[72:75]
    ds_read_b128 v[144:147], v16 offset:36416
    v_mfma_f32_16x16x32_bf16 v[76:79], a[52:55], v[124:127], v[76:79]
    s_add_u32 m0, s76, 139008
    s_nop 0
    buffer_load_dwordx4 v248, s[16:19], s44 offen lds
    v_mfma_f32_16x16x32_bf16 v[80:83], a[56:59], v[124:127], v[80:83]
    s_waitcnt lgkmcnt(5)
    s_waitcnt vmcnt(5)
    s_barrier
    s_waitcnt lgkmcnt(2)
    v_mfma_f32_16x16x32_bf16 v[24:27], a[60:63], v[128:131], v[24:27]
    ds_read_b64_tr_b16 a[72:73], v19 offset:0
    v_mfma_f32_16x16x32_bf16 v[28:31], a[64:67], v[128:131], v[28:31]
    ds_read_b64_tr_b16 a[74:75], v19 offset:768
    v_mfma_f32_16x16x32_bf16 v[32:35], a[68:71], v[128:131], v[32:35]
    ds_read_b64_tr_b16 a[76:77], v19 offset:32
    v_mfma_f32_16x16x32_bf16 v[36:39], a[60:63], v[132:135], v[36:39]
    ds_read_b64_tr_b16 a[78:79], v19 offset:800
    v_mfma_f32_16x16x32_bf16 v[40:43], a[64:67], v[132:135], v[40:43]
    ds_read_b64_tr_b16 a[80:81], v19 offset:64
    v_mfma_f32_16x16x32_bf16 v[44:47], a[68:71], v[132:135], v[44:47]
    s_add_u32 m0, s43, 53760
    v_add_u32 v5, s74, v10
    s_mov_b64 exec, s[34:35]
    buffer_load_dwordx4 v5, s[12:15], 0 offen lds
    s_mov_b64 exec, -1
    v_mfma_f32_16x16x32_bf16 v[48:51], a[60:63], v[136:139], v[48:51]
    ds_read_b64_tr_b16 a[82:83], v19 offset:832
    v_mfma_f32_16x16x32_bf16 v[52:55], a[64:67], v[136:139], v[52:55]
    ds_read_b128 v[108:111], v16 offset:896
    v_mfma_f32_16x16x32_bf16 v[56:59], a[68:71], v[136:139], v[56:59]
    ds_read_b128 v[112:115], v16 offset:9856
    s_waitcnt lgkmcnt(8)
    v_mfma_f32_16x16x32_bf16 v[60:63], a[60:63], v[140:143], v[60:63]
    ds_read_b128 v[116:119], v16 offset:18816
    v_mfma_f32_16x16x32_bf16 v[64:67], a[64:67], v[140:143], v[64:67]
    ds_read_b128 v[120:123], v16 offset:27776
    v_mfma_f32_16x16x32_bf16 v[68:71], a[68:71], v[140:143], v[68:71]
    s_add_u32 m0, s43, 54656
    v_add_u32 v5, s74, v11
    s_mov_b64 exec, s[34:35]
    buffer_load_dwordx4 v5, s[12:15], 0 offen lds
    s_mov_b64 exec, -1
    v_mfma_f32_16x16x32_bf16 v[72:75], a[60:63], v[144:147], v[72:75]
    ds_read_b128 v[124:127], v16 offset:36736
    v_mfma_f32_16x16x32_bf16 v[76:79], a[64:67], v[144:147], v[76:79]
    v_mfma_f32_16x16x32_bf16 v[80:83], a[68:71], v[144:147], v[80:83]
    s_waitcnt lgkmcnt(2)
    v_mfma_f32_16x16x32_bf16 v[24:27], a[72:75], v[108:111], v[24:27]
    ds_read_b64_tr_b16 a[84:85], v19 offset:6272
    v_mfma_f32_16x16x32_bf16 v[28:31], a[76:79], v[108:111], v[28:31]
    ds_read_b64_tr_b16 a[86:87], v19 offset:7040
    v_mfma_f32_16x16x32_bf16 v[32:35], a[80:83], v[108:111], v[32:35]
    ds_read_b64_tr_b16 a[88:89], v19 offset:6304
    v_mfma_f32_16x16x32_bf16 v[36:39], a[72:75], v[112:115], v[36:39]
    s_mov_b32 s44, 73728
    s_add_u32 m0, s42, 80640
    s_nop 0
    buffer_load_dwordx4 v244, s[16:19], s44 offen lds
    v_mfma_f32_16x16x32_bf16 v[40:43], a[76:79], v[112:115], v[40:43]
    ds_read_b64_tr_b16 a[90:91], v19 offset:7072
    v_mfma_f32_16x16x32_bf16 v[44:47], a[80:83], v[112:115], v[44:47]
    ds_read_b64_tr_b16 a[92:93], v19 offset:6336
    v_mfma_f32_16x16x32_bf16 v[48:51], a[72:75], v[116:119], v[48:51]
    ds_read_b64_tr_b16 a[94:95], v19 offset:7104
    v_mfma_f32_16x16x32_bf16 v[52:55], a[76:79], v[116:119], v[52:55]
    ds_read_b128 v[128:131], v16 offset:960
    v_mfma_f32_16x16x32_bf16 v[56:59], a[80:83], v[116:119], v[56:59]
    ds_read_b128 v[132:135], v16 offset:9920
    s_waitcnt lgkmcnt(8)
    v_mfma_f32_16x16x32_bf16 v[60:63], a[72:75], v[120:123], v[60:63]
    s_add_u32 m0, s42, 81664
    s_nop 0
    buffer_load_dwordx4 v245, s[16:19], s44 offen lds
    v_mfma_f32_16x16x32_bf16 v[64:67], a[76:79], v[120:123], v[64:67]
    ds_read_b128 v[136:139], v16 offset:18880
    v_mfma_f32_16x16x32_bf16 v[68:71], a[80:83], v[120:123], v[68:71]
    ds_read_b128 v[140:143], v16 offset:27840
    v_mfma_f32_16x16x32_bf16 v[72:75], a[72:75], v[124:127], v[72:75]
    ds_read_b128 v[144:147], v16 offset:36800
    v_mfma_f32_16x16x32_bf16 v[76:79], a[76:79], v[124:127], v[76:79]
    v_mfma_f32_16x16x32_bf16 v[80:83], a[80:83], v[124:127], v[80:83]
    s_waitcnt lgkmcnt(2)
    v_mfma_f32_16x16x32_bf16 v[24:27], a[84:87], v[128:131], v[24:27]
    ds_read_b64_tr_b16 a[96:97], v19 offset:12544
    v_mfma_f32_16x16x32_bf16 v[28:31], a[88:91], v[128:131], v[28:31]
    s_add_u32 m0, s42, 82688
    s_nop 0
    buffer_load_dwordx4 v246, s[16:19], s44 offen lds
    v_mfma_f32_16x16x32_bf16 v[32:35], a[92:95], v[128:131], v[32:35]
    ds_read_b64_tr_b16 a[98:99], v19 offset:13312
    v_mfma_f32_16x16x32_bf16 v[36:39], a[84:87], v[132:135], v[36:39]
    ds_read_b64_tr_b16 a[100:101], v19 offset:12576
    v_mfma_f32_16x16x32_bf16 v[40:43], a[88:91], v[132:135], v[40:43]
    ds_read_b64_tr_b16 a[102:103], v19 offset:13344
    v_mfma_f32_16x16x32_bf16 v[44:47], a[92:95], v[132:135], v[44:47]
    ds_read_b64_tr_b16 a[104:105], v19 offset:12608
    v_mfma_f32_16x16x32_bf16 v[48:51], a[84:87], v[136:139], v[48:51]
    ds_read_b64_tr_b16 a[106:107], v19 offset:13376
    v_mfma_f32_16x16x32_bf16 v[52:55], a[88:91], v[136:139], v[52:55]
    s_add_u32 m0, s42, 83712
    s_nop 0
    buffer_load_dwordx4 v247, s[16:19], s44 offen lds
    v_mfma_f32_16x16x32_bf16 v[56:59], a[92:95], v[136:139], v[56:59]
    ds_read_b128 v[108:111], v16 offset:1024
    s_waitcnt lgkmcnt(7)
    v_mfma_f32_16x16x32_bf16 v[60:63], a[84:87], v[140:143], v[60:63]
    ds_read_b128 v[112:115], v16 offset:9984
    v_mfma_f32_16x16x32_bf16 v[64:67], a[88:91], v[140:143], v[64:67]
    ds_read_b128 v[116:119], v16 offset:18944
    v_mfma_f32_16x16x32_bf16 v[68:71], a[92:95], v[140:143], v[68:71]
    ds_read_b128 v[120:123], v16 offset:27904
    v_mfma_f32_16x16x32_bf16 v[72:75], a[84:87], v[144:147], v[72:75]
    ds_read_b128 v[124:127], v16 offset:36864
    v_mfma_f32_16x16x32_bf16 v[76:79], a[88:91], v[144:147], v[76:79]
    s_add_u32 m0, s76, 80640
    s_nop 0
    buffer_load_dwordx4 v248, s[16:19], s44 offen lds
    v_mfma_f32_16x16x32_bf16 v[80:83], a[92:95], v[144:147], v[80:83]
    s_waitcnt lgkmcnt(5)
    s_waitcnt vmcnt(7)
    s_barrier
    s_waitcnt lgkmcnt(2)
    v_mfma_f32_16x16x32_bf16 v[24:27], a[96:99], v[108:111], v[24:27]
    ds_read_b64_tr_b16 a[108:109], v19 offset:19456
    v_mfma_f32_16x16x32_bf16 v[28:31], a[100:103], v[108:111], v[28:31]
    ds_read_b64_tr_b16 a[110:111], v19 offset:20224
    v_mfma_f32_16x16x32_bf16 v[32:35], a[104:107], v[108:111], v[32:35]
    ds_read_b64_tr_b16 a[112:113], v19 offset:19488
    v_mfma_f32_16x16x32_bf16 v[36:39], a[96:99], v[112:115], v[36:39]
    ds_read_b64_tr_b16 a[114:115], v19 offset:20256
    v_mfma_f32_16x16x32_bf16 v[40:43], a[100:103], v[112:115], v[40:43]
    ds_read_b64_tr_b16 a[116:117], v19 offset:19520
    v_mfma_f32_16x16x32_bf16 v[44:47], a[104:107], v[112:115], v[44:47]
    s_add_u32 m0, s43, 55552
    v_add_u32 v5, s74, v12
    s_mov_b64 exec, s[34:35]
    buffer_load_dwordx4 v5, s[12:15], 0 offen lds
    s_mov_b64 exec, -1
    v_mfma_f32_16x16x32_bf16 v[48:51], a[96:99], v[116:119], v[48:51]
    ds_read_b64_tr_b16 a[118:119], v19 offset:20288
    v_mfma_f32_16x16x32_bf16 v[52:55], a[100:103], v[116:119], v[52:55]
    ds_read_b128 v[128:131], v16 offset:8960
    v_mfma_f32_16x16x32_bf16 v[56:59], a[104:107], v[116:119], v[56:59]
    ds_read_b128 v[132:135], v16 offset:17920
    s_waitcnt lgkmcnt(8)
    v_mfma_f32_16x16x32_bf16 v[60:63], a[96:99], v[120:123], v[60:63]
    ds_read_b128 v[136:139], v16 offset:26880
    v_mfma_f32_16x16x32_bf16 v[64:67], a[100:103], v[120:123], v[64:67]
    ds_read_b128 v[140:143], v16 offset:35840
    v_mfma_f32_16x16x32_bf16 v[68:71], a[104:107], v[120:123], v[68:71]
    s_add_u32 m0, s43, 56448
    v_add_u32 v5, s74, v13
    s_mov_b64 exec, s[34:35]
    buffer_load_dwordx4 v5, s[12:15], 0 offen lds
    s_mov_b64 exec, -1
    v_mfma_f32_16x16x32_bf16 v[72:75], a[96:99], v[124:127], v[72:75]
    ds_read_b128 v[144:147], v16 offset:44800
    v_mfma_f32_16x16x32_bf16 v[76:79], a[100:103], v[124:127], v[76:79]
    v_mfma_f32_16x16x32_bf16 v[80:83], a[104:107], v[124:127], v[80:83]
    s_waitcnt lgkmcnt(2)
    v_mfma_f32_16x16x32_bf16 v[24:27], a[108:111], v[128:131], v[24:27]
    ds_read_b64_tr_b16 a[120:121], v19 offset:25728
    v_mfma_f32_16x16x32_bf16 v[28:31], a[112:115], v[128:131], v[28:31]
    ds_read_b64_tr_b16 a[122:123], v19 offset:26496
    v_mfma_f32_16x16x32_bf16 v[32:35], a[116:119], v[128:131], v[32:35]
    ds_read_b64_tr_b16 a[124:125], v19 offset:25760
    v_mfma_f32_16x16x32_bf16 v[36:39], a[108:111], v[132:135], v[36:39]
    s_mov_b32 s44, 92160
    s_add_u32 m0, s42, 100096
    s_nop 0
    buffer_load_dwordx4 v244, s[16:19], s44 offen lds
    v_mfma_f32_16x16x32_bf16 v[40:43], a[112:115], v[132:135], v[40:43]
    ds_read_b64_tr_b16 a[126:127], v19 offset:26528
    v_mfma_f32_16x16x32_bf16 v[44:47], a[116:119], v[132:135], v[44:47]
    ds_read_b64_tr_b16 a[128:129], v19 offset:25792
    v_mfma_f32_16x16x32_bf16 v[48:51], a[108:111], v[136:139], v[48:51]
    ds_read_b64_tr_b16 a[130:131], v19 offset:26560
    v_mfma_f32_16x16x32_bf16 v[52:55], a[112:115], v[136:139], v[52:55]
    ds_read_b128 v[108:111], v16 offset:9024
    v_mfma_f32_16x16x32_bf16 v[56:59], a[116:119], v[136:139], v[56:59]
    ds_read_b128 v[112:115], v16 offset:17984
    s_waitcnt lgkmcnt(8)
    v_mfma_f32_16x16x32_bf16 v[60:63], a[108:111], v[140:143], v[60:63]
    s_add_u32 m0, s42, 101120
    s_nop 0
    buffer_load_dwordx4 v245, s[16:19], s44 offen lds
    v_mfma_f32_16x16x32_bf16 v[64:67], a[112:115], v[140:143], v[64:67]
    ds_read_b128 v[116:119], v16 offset:26944
    v_mfma_f32_16x16x32_bf16 v[68:71], a[116:119], v[140:143], v[68:71]
    ds_read_b128 v[120:123], v16 offset:35904
    v_mfma_f32_16x16x32_bf16 v[72:75], a[108:111], v[144:147], v[72:75]
    ds_read_b128 v[124:127], v16 offset:44864
    v_mfma_f32_16x16x32_bf16 v[76:79], a[112:115], v[144:147], v[76:79]
    v_mfma_f32_16x16x32_bf16 v[80:83], a[116:119], v[144:147], v[80:83]
    s_waitcnt lgkmcnt(2)
    v_mfma_f32_16x16x32_bf16 v[24:27], a[120:123], v[108:111], v[24:27]
    ds_read_b64_tr_b16 a[132:133], v19 offset:32000
    v_mfma_f32_16x16x32_bf16 v[28:31], a[124:127], v[108:111], v[28:31]
    s_add_u32 m0, s42, 102144
    s_nop 0
    buffer_load_dwordx4 v246, s[16:19], s44 offen lds
    v_mfma_f32_16x16x32_bf16 v[32:35], a[128:131], v[108:111], v[32:35]
    ds_read_b64_tr_b16 a[134:135], v19 offset:32768
    v_mfma_f32_16x16x32_bf16 v[36:39], a[120:123], v[112:115], v[36:39]
    ds_read_b64_tr_b16 a[136:137], v19 offset:32032
    v_mfma_f32_16x16x32_bf16 v[40:43], a[124:127], v[112:115], v[40:43]
    ds_read_b64_tr_b16 a[138:139], v19 offset:32800
    v_mfma_f32_16x16x32_bf16 v[44:47], a[128:131], v[112:115], v[44:47]
    ds_read_b64_tr_b16 a[140:141], v19 offset:32064
    v_mfma_f32_16x16x32_bf16 v[48:51], a[120:123], v[116:119], v[48:51]
    ds_read_b64_tr_b16 a[142:143], v19 offset:32832
    v_mfma_f32_16x16x32_bf16 v[52:55], a[124:127], v[116:119], v[52:55]
    s_add_u32 m0, s42, 103168
    s_nop 0
    buffer_load_dwordx4 v247, s[16:19], s44 offen lds
    v_mfma_f32_16x16x32_bf16 v[56:59], a[128:131], v[116:119], v[56:59]
    ds_read_b128 v[128:131], v16 offset:9088
    s_waitcnt lgkmcnt(7)
    v_mfma_f32_16x16x32_bf16 v[60:63], a[120:123], v[120:123], v[60:63]
    ds_read_b128 v[132:135], v16 offset:18048
    v_mfma_f32_16x16x32_bf16 v[64:67], a[124:127], v[120:123], v[64:67]
    ds_read_b128 v[136:139], v16 offset:27008
    v_mfma_f32_16x16x32_bf16 v[68:71], a[128:131], v[120:123], v[68:71]
    ds_read_b128 v[140:143], v16 offset:35968
    v_mfma_f32_16x16x32_bf16 v[72:75], a[120:123], v[124:127], v[72:75]
    ds_read_b128 v[144:147], v16 offset:44928
    v_mfma_f32_16x16x32_bf16 v[76:79], a[124:127], v[124:127], v[76:79]
    s_add_u32 m0, s76, 100096
    s_nop 0
    buffer_load_dwordx4 v248, s[16:19], s44 offen lds
    v_mfma_f32_16x16x32_bf16 v[80:83], a[128:131], v[124:127], v[80:83]
    s_waitcnt lgkmcnt(5)
    s_waitcnt vmcnt(7)
    s_barrier
    s_waitcnt lgkmcnt(2)
    v_mfma_f32_16x16x32_bf16 v[24:27], a[132:135], v[128:131], v[24:27]
    ds_read_b64_tr_b16 a[144:145], v18 offset:0
    v_mfma_f32_16x16x32_bf16 v[28:31], a[136:139], v[128:131], v[28:31]
    ds_read_b64_tr_b16 a[146:147], v18 offset:768
    v_mfma_f32_16x16x32_bf16 v[32:35], a[140:143], v[128:131], v[32:35]
    ds_read_b64_tr_b16 a[148:149], v18 offset:32
    v_mfma_f32_16x16x32_bf16 v[36:39], a[132:135], v[132:135], v[36:39]
    ds_read_b64_tr_b16 a[150:151], v18 offset:800
    v_mfma_f32_16x16x32_bf16 v[40:43], a[136:139], v[132:135], v[40:43]
    ds_read_b64_tr_b16 a[152:153], v18 offset:64
    v_mfma_f32_16x16x32_bf16 v[44:47], a[140:143], v[132:135], v[44:47]
    s_add_u32 m0, s43, 57344
    v_add_u32 v5, s74, v14
    s_mov_b64 exec, s[34:35]
    buffer_load_dwordx4 v5, s[12:15], 0 offen lds
    s_mov_b64 exec, -1
    v_mfma_f32_16x16x32_bf16 v[48:51], a[132:135], v[136:139], v[48:51]
    ds_read_b64_tr_b16 a[154:155], v18 offset:832
    v_mfma_f32_16x16x32_bf16 v[52:55], a[136:139], v[136:139], v[52:55]
    ds_read_b128 v[108:111], v16 offset:9408
    v_mfma_f32_16x16x32_bf16 v[56:59], a[140:143], v[136:139], v[56:59]
    ds_read_b128 v[112:115], v16 offset:18368
    s_waitcnt lgkmcnt(8)
    v_mfma_f32_16x16x32_bf16 v[60:63], a[132:135], v[140:143], v[60:63]
    ds_read_b128 v[116:119], v16 offset:27328
    v_mfma_f32_16x16x32_bf16 v[64:67], a[136:139], v[140:143], v[64:67]
    ds_read_b128 v[120:123], v16 offset:36288
    v_mfma_f32_16x16x32_bf16 v[68:71], a[140:143], v[140:143], v[68:71]
    s_cmp_ge_u32 s24, 2
    s_cbranch_scc1 L_skip1
    s_add_u32 m0, s43, 71680
    v_add_u32 v5, s75, v10
    s_mov_b64 exec, s[34:35]
    buffer_load_dwordx4 v5, s[12:15], 0 offen lds
    s_mov_b64 exec, -1
L_skip1:
    v_mfma_f32_16x16x32_bf16 v[72:75], a[132:135], v[144:147], v[72:75]
    ds_read_b128 v[124:127], v16 offset:45248
    v_mfma_f32_16x16x32_bf16 v[76:79], a[136:139], v[144:147], v[76:79]
    v_mfma_f32_16x16x32_bf16 v[80:83], a[140:143], v[144:147], v[80:83]
    s_waitcnt lgkmcnt(2)
    v_mfma_f32_16x16x32_bf16 v[24:27], a[144:147], v[108:111], v[24:27]
    ds_read_b64_tr_b16 a[156:157], v18 offset:6272
    v_mfma_f32_16x16x32_bf16 v[28:31], a[148:151], v[108:111], v[28:31]
    ds_read_b64_tr_b16 a[158:159], v18 offset:7040
    v_mfma_f32_16x16x32_bf16 v[32:35], a[152:155], v[108:111], v[32:35]
    ds_read_b64_tr_b16 a[160:161], v18 offset:6304
    v_mfma_f32_16x16x32_bf16 v[36:39], a[144:147], v[112:115], v[36:39]
    s_mov_b32 s44, 110592
    s_add_u32 m0, s42, 119552
    s_nop 0
    buffer_load_dwordx4 v244, s[16:19], s44 offen lds
    v_mfma_f32_16x16x32_bf16 v[40:43], a[148:151], v[112:115], v[40:43]
    ds_read_b64_tr_b16 a[162:163], v18 offset:7072
    v_mfma_f32_16x16x32_bf16 v[44:47], a[152:155], v[112:115], v[44:47]
    ds_read_b64_tr_b16 a[164:165], v18 offset:6336
    v_mfma_f32_16x16x32_bf16 v[48:51], a[144:147], v[116:119], v[48:51]
    ds_read_b64_tr_b16 a[166:167], v18 offset:7104
    v_mfma_f32_16x16x32_bf16 v[52:55], a[148:151], v[116:119], v[52:55]
    ds_read_b128 v[128:131], v16 offset:9472
    v_mfma_f32_16x16x32_bf16 v[56:59], a[152:155], v[116:119], v[56:59]
    ds_read_b128 v[132:135], v16 offset:18432
    s_waitcnt lgkmcnt(8)
    v_mfma_f32_16x16x32_bf16 v[60:63], a[144:147], v[120:123], v[60:63]
    s_add_u32 m0, s42, 120576
    s_nop 0
    buffer_load_dwordx4 v245, s[16:19], s44 offen lds
    v_mfma_f32_16x16x32_bf16 v[64:67], a[148:151], v[120:123], v[64:67]
    ds_read_b128 v[136:139], v16 offset:27392
    v_mfma_f32_16x16x32_bf16 v[68:71], a[152:155], v[120:123], v[68:71]
    ds_read_b128 v[140:143], v16 offset:36352
    v_mfma_f32_16x16x32_bf16 v[72:75], a[144:147], v[124:127], v[72:75]
    ds_read_b128 v[144:147], v16 offset:45312
    v_mfma_f32_16x16x32_bf16 v[76:79], a[148:151], v[124:127], v[76:79]
    v_mfma_f32_16x16x32_bf16 v[80:83], a[152:155], v[124:127], v[80:83]
    s_waitcnt lgkmcnt(2)
    v_mfma_f32_16x16x32_bf16 v[24:27], a[156:159], v[128:131], v[24:27]
    ds_read_b64_tr_b16 a[168:169], v18 offset:12544
    v_mfma_f32_16x16x32_bf16 v[28:31], a[160:163], v[128:131], v[28:31]
    s_add_u32 m0, s42, 121600
    s_nop 0
    buffer_load_dwordx4 v246, s[16:19], s44 offen lds
    v_mfma_f32_16x16x32_bf16 v[32:35], a[164:167], v[128:131], v[32:35]
    ds_read_b64_tr_b16 a[170:171], v18 offset:13312
    v_mfma_f32_16x16x32_bf16 v[36:39], a[156:159], v[132:135], v[36:39]
    ds_read_b64_tr_b16 a[172:173], v18 offset:12576
    v_mfma_f32_16x16x32_bf16 v[40:43], a[160:163], v[132:135], v[40:43]
    ds_read_b64_tr_b16 a[174:175], v18 offset:13344
    v_mfma_f32_16x16x32_bf16 v[44:47], a[164:167], v[132:135], v[44:47]
    ds_read_b64_tr_b16 a[176:177], v18 offset:12608
    v_mfma_f32_16x16x32_bf16 v[48:51], a[156:159], v[136:139], v[48:51]
    ds_read_b64_tr_b16 a[178:179], v18 offset:13376
    v_mfma_f32_16x16x32_bf16 v[52:55], a[160:163], v[136:139], v[52:55]
    s_add_u32 m0, s42, 122624
    s_nop 0
    buffer_load_dwordx4 v247, s[16:19], s44 offen lds
    v_mfma_f32_16x16x32_bf16 v[56:59], a[164:167], v[136:139], v[56:59]
    ds_read_b128 v[108:111], v16 offset:9536
    s_waitcnt lgkmcnt(7)
    v_mfma_f32_16x16x32_bf16 v[60:63], a[156:159], v[140:143], v[60:63]
    ds_read_b128 v[112:115], v16 offset:18496
    v_mfma_f32_16x16x32_bf16 v[64:67], a[160:163], v[140:143], v[64:67]
    ds_read_b128 v[116:119], v16 offset:27456
    v_mfma_f32_16x16x32_bf16 v[68:71], a[164:167], v[140:143], v[68:71]
    ds_read_b128 v[120:123], v16 offset:36416
    v_mfma_f32_16x16x32_bf16 v[72:75], a[156:159], v[144:147], v[72:75]
    ds_read_b128 v[124:127], v16 offset:45376
    v_mfma_f32_16x16x32_bf16 v[76:79], a[160:163], v[144:147], v[76:79]
    s_add_u32 m0, s76, 119552
    s_nop 0
    buffer_load_dwordx4 v248, s[16:19], s44 offen lds
    v_mfma_f32_16x16x32_bf16 v[80:83], a[164:167], v[144:147], v[80:83]
    s_waitcnt lgkmcnt(5)
    s_waitcnt vmcnt(6)
    s_barrier
    s_waitcnt lgkmcnt(2)
    v_mfma_f32_16x16x32_bf16 v[24:27], a[168:171], v[108:111], v[24:27]
    ds_read_b64_tr_b16 a[180:181], v18 offset:19456
    v_mfma_f32_16x16x32_bf16 v[28:31], a[172:175], v[108:111], v[28:31]
    ds_read_b64_tr_b16 a[182:183], v18 offset:20224
    v_mfma_f32_16x16x32_bf16 v[32:35], a[176:179], v[108:111], v[32:35]
    ds_read_b64_tr_b16 a[184:185], v18 offset:19488
    v_mfma_f32_16x16x32_bf16 v[36:39], a[168:171], v[112:115], v[36:39]
    ds_read_b64_tr_b16 a[186:187], v18 offset:20256
    v_mfma_f32_16x16x32_bf16 v[40:43], a[172:175], v[112:115], v[40:43]
    ds_read_b64_tr_b16 a[188:189], v18 offset:19520
    v_mfma_f32_16x16x32_bf16 v[44:47], a[176:179], v[112:115], v[44:47]
    s_cmp_ge_u32 s24, 2
    s_cbranch_scc1 L_skip2
    s_add_u32 m0, s43, 72576
    v_add_u32 v5, s75, v11
    s_mov_b64 exec, s[34:35]
    buffer_load_dwordx4 v5, s[12:15], 0 offen lds
    s_mov_b64 exec, -1
L_skip2:
    v_mfma_f32_16x16x32_bf16 v[48:51], a[168:171], v[116:119], v[48:51]
    ds_read_b64_tr_b16 a[190:191], v18 offset:20288
    v_mfma_f32_16x16x32_bf16 v[52:55], a[172:175], v[116:119], v[52:55]
    ds_read_b128 v[128:131], v16 offset:9856
    v_mfma_f32_16x16x32_bf16 v[56:59], a[176:179], v[116:119], v[56:59]
    ds_read_b128 v[132:135], v16 offset:18816
    s_waitcnt lgkmcnt(8)
    v_mfma_f32_16x16x32_bf16 v[60:63], a[168:171], v[120:123], v[60:63]
    ds_read_b128 v[136:139], v16 offset:27776
    v_mfma_f32_16x16x32_bf16 v[64:67], a[172:175], v[120:123], v[64:67]
    ds_read_b128 v[140:143], v16 offset:36736
    v_mfma_f32_16x16x32_bf16 v[68:71], a[176:179], v[120:123], v[68:71]
    s_cmp_ge_u32 s24, 2
    s_cbranch_scc1 L_skip3
    s_add_u32 m0, s43, 73472
    v_add_u32 v5, s75, v12
    s_mov_b64 exec, s[34:35]
    buffer_load_dwordx4 v5, s[12:15], 0 offen lds
    s_mov_b64 exec, -1
L_skip3:
    v_mfma_f32_16x16x32_bf16 v[72:75], a[168:171], v[124:127], v[72:75]
    ds_read_b128 v[144:147], v16 offset:45696
    v_mfma_f32_16x16x32_bf16 v[76:79], a[172:175], v[124:127], v[76:79]
    v_mfma_f32_16x16x32_bf16 v[80:83], a[176:179], v[124:127], v[80:83]
    s_waitcnt lgkmcnt(2)
    v_mfma_f32_16x16x32_bf16 v[24:27], a[180:183], v[128:131], v[24:27]
    ds_read_b64_tr_b16 a[192:193], v18 offset:25728
    v_mfma_f32_16x16x32_bf16 v[28:31], a[184:187], v[128:131], v[28:31]
    ds_read_b64_tr_b16 a[194:195], v18 offset:26496
    v_mfma_f32_16x16x32_bf16 v[32:35], a[188:191], v[128:131], v[32:35]
    ds_read_b64_tr_b16 a[196:197], v18 offset:25760
    v_mfma_f32_16x16x32_bf16 v[36:39], a[180:183], v[132:135], v[36:39]
    s_mov_b32 s44, 129024
    s_add_u32 m0, s42, 139008
    s_nop 0
    buffer_load_dwordx4 v244, s[16:19], s44 offen lds
    v_mfma_f32_16x16x32_bf16 v[40:43], a[184:187], v[132:135], v[40:43]
    ds_read_b64_tr_b16 a[198:199], v18 offset:26528
    v_mfma_f32_16x16x32_bf16 v[44:47], a[188:191], v[132:135], v[44:47]
    ds_read_b64_tr_b16 a[200:201], v18 offset:25792
    v_mfma_f32_16x16x32_bf16 v[48:51], a[180:183], v[136:139], v[48:51]
    ds_read_b64_tr_b16 a[202:203], v18 offset:26560
    v_mfma_f32_16x16x32_bf16 v[52:55], a[184:187], v[136:139], v[52:55]
    ds_read_b128 v[108:111], v16 offset:9920
    v_mfma_f32_16x16x32_bf16 v[56:59], a[188:191], v[136:139], v[56:59]
    ds_read_b128 v[112:115], v16 offset:18880
    s_waitcnt lgkmcnt(8)
    v_mfma_f32_16x16x32_bf16 v[60:63], a[180:183], v[140:143], v[60:63]
    s_add_u32 m0, s42, 140032
    s_nop 0
    buffer_load_dwordx4 v245, s[16:19], s44 offen lds
    v_mfma_f32_16x16x32_bf16 v[64:67], a[184:187], v[140:143], v[64:67]
    ds_read_b128 v[116:119], v16 offset:27840
    v_mfma_f32_16x16x32_bf16 v[68:71], a[188:191], v[140:143], v[68:71]
    ds_read_b128 v[120:123], v16 offset:36800
    v_mfma_f32_16x16x32_bf16 v[72:75], a[180:183], v[144:147], v[72:75]
    ds_read_b128 v[124:127], v16 offset:45760
    v_mfma_f32_16x16x32_bf16 v[76:79], a[184:187], v[144:147], v[76:79]
    v_mfma_f32_16x16x32_bf16 v[80:83], a[188:191], v[144:147], v[80:83]
    s_waitcnt lgkmcnt(2)
    v_mfma_f32_16x16x32_bf16 v[24:27], a[192:195], v[108:111], v[24:27]
    ds_read_b64_tr_b16 a[204:205], v18 offset:32000
    v_mfma_f32_16x16x32_bf16 v[28:31], a[196:199], v[108:111], v[28:31]
    s_add_u32 m0, s42, 141056
    s_nop 0
    buffer_load_dwordx4 v246, s[16:19], s44 offen lds
    v_mfma_f32_16x16x32_bf16 v[32:35], a[200:203], v[108:111], v[32:35]
    ds_read_b64_tr_b16 a[206:207], v18 offset:32768
    v_mfma_f32_16x16x32_bf16 v[36:39], a[192:195], v[112:115], v[36:39]
    ds_read_b64_tr_b16 a[208:209], v18 offset:32032
    v_mfma_f32_16x16x32_bf16 v[40:43], a[196:199], v[112:115], v[40:43]
    ds_read_b64_tr_b16 a[210:211], v18 offset:32800
    v_mfma_f32_16x16x32_bf16 v[44:47], a[200:203], v[112:115], v[44:47]
    ds_read_b64_tr_b16 a[212:213], v18 offset:32064
    v_mfma_f32_16x16x32_bf16 v[48:51], a[192:195], v[116:119], v[48:51]
    ds_read_b64_tr_b16 a[214:215], v18 offset:32832
    v_mfma_f32_16x16x32_bf16 v[52:55], a[196:199], v[116:119], v[52:55]
    s_add_u32 m0, s42, 142080
    s_nop 0
    buffer_load_dwordx4 v247, s[16:19], s44 offen lds
    v_mfma_f32_16x16x32_bf16 v[56:59], a[200:203], v[116:119], v[56:59]
    ds_read_b128 v[128:131], v16 offset:9984
    s_waitcnt lgkmcnt(7)
    v_mfma_f32_16x16x32_bf16 v[60:63], a[192:195], v[120:123], v[60:63]
    ds_read_b128 v[132:135], v16 offset:18944
    v_mfma_f32_16x16x32_bf16 v[64:67], a[196:199], v[120:123], v[64:67]
    ds_read_b128 v[136:139], v16 offset:27904
    v_mfma_f32_16x16x32_bf16 v[68:71], a[200:203], v[120:123], v[68:71]
    ds_read_b128 v[140:143], v16 offset:36864
    v_mfma_f32_16x16x32_bf16 v[72:75], a[192:195], v[124:127], v[72:75]
    ds_read_b128 v[144:147], v16 offset:45824
    v_mfma_f32_16x16x32_bf16 v[76:79], a[196:199], v[124:127], v[76:79]
    s_add_u32 m0, s76, 139008
    s_nop 0
    buffer_load_dwordx4 v248, s[16:19], s44 offen lds
    v_mfma_f32_16x16x32_bf16 v[80:83], a[200:203], v[124:127], v[80:83]
    s_waitcnt lgkmcnt(5)
    s_waitcnt vmcnt(5)
    s_barrier
    s_waitcnt lgkmcnt(2)
    v_mfma_f32_16x16x32_bf16 v[24:27], a[204:207], v[128:131], v[24:27]
    ds_read_b64_tr_b16 a[216:217], v19 offset:0
    v_mfma_f32_16x16x32_bf16 v[28:31], a[208:211], v[128:131], v[28:31]
    ds_read_b64_tr_b16 a[218:219], v19 offset:768
    v_mfma_f32_16x16x32_bf16 v[32:35], a[212:215], v[128:131], v[32:35]
    ds_read_b64_tr_b16 a[220:221], v19 offset:32
    v_mfma_f32_16x16x32_bf16 v[36:39], a[204:207], v[132:135], v[36:39]
    ds_read_b64_tr_b16 a[222:223], v19 offset:800
    v_mfma_f32_16x16x32_bf16 v[40:43], a[208:211], v[132:135], v[40:43]
    ds_read_b64_tr_b16 a[224:225], v19 offset:64
    v_mfma_f32_16x16x32_bf16 v[44:47], a[212:215], v[132:135], v[44:47]
    s_cmp_ge_u32 s24, 2
    s_cbranch_scc1 L_skip4
    s_add_u32 m0, s43, 74368
    v_add_u32 v5, s75, v13
    s_mov_b64 exec, s[34:35]
    buffer_load_dwordx4 v5, s[12:15], 0 offen lds
    s_mov_b64 exec, -1
L_skip4:
    v_mfma_f32_16x16x32_bf16 v[48:51], a[204:207], v[136:139], v[48:51]
    ds_read_b64_tr_b16 a[226:227], v19 offset:832
    v_mfma_f32_16x16x32_bf16 v[52:55], a[208:211], v[136:139], v[52:55]
    ds_read_b128 v[108:111], v16 offset:17920
    v_mfma_f32_16x16x32_bf16 v[56:59], a[212:215], v[136:139], v[56:59]
    ds_read_b128 v[112:115], v16 offset:26880
    s_waitcnt lgkmcnt(8)
    v_mfma_f32_16x16x32_bf16 v[60:63], a[204:207], v[140:143], v[60:63]
    ds_read_b128 v[116:119], v16 offset:35840
    v_mfma_f32_16x16x32_bf16 v[64:67], a[208:211], v[140:143], v[64:67]
    ds_read_b128 v[120:123], v16 offset:44800
    v_mfma_f32_16x16x32_bf16 v[68:71], a[212:215], v[140:143], v[68:71]
    s_cmp_ge_u32 s24, 2
    s_cbranch_scc1 L_skip5
    s_add_u32 m0, s43, 75264
    v_add_u32 v5, s75, v14
    s_mov_b64 exec, s[34:35]
    buffer_load_dwordx4 v5, s[12:15], 0 offen lds
    s_mov_b64 exec, -1
L_skip5:
    v_mfma_f32_16x16x32_bf16 v[72:75], a[204:207], v[144:147], v[72:75]
    ds_read_b128 v[124:127], v16 offset:53760
    v_mfma_f32_16x16x32_bf16 v[76:79], a[208:211], v[144:147], v[76:79]
    v_mfma_f32_16x16x32_bf16 v[80:83], a[212:215], v[144:147], v[80:83]
    s_waitcnt lgkmcnt(2)
    v_mfma_f32_16x16x32_bf16 v[24:27], a[216:219], v[108:111], v[24:27]
    ds_read_b64_tr_b16 a[228:229], v19 offset:6272
    v_mfma_f32_16x16x32_bf16 v[28:31], a[220:223], v[108:111], v[28:31]
    ds_read_b64_tr_b16 a[230:231], v19 offset:7040
    v_mfma_f32_16x16x32_bf16 v[32:35], a[224:227], v[108:111], v[32:35]
    ds_read_b64_tr_b16 a[232:233], v19 offset:6304
    v_mfma_f32_16x16x32_bf16 v[36:39], a[216:219], v[112:115], v[36:39]
    ds_read_b64_tr_b16 a[234:235], v19 offset:7072
    v_mfma_f32_16x16x32_bf16 v[40:43], a[220:223], v[112:115], v[40:43]
    s_mov_b32 s44, 147456
    s_add_u32 m0, s42, 80640
    s_nop 0
    buffer_load_dwordx4 v244, s[16:19], s44 offen lds
    v_mfma_f32_16x16x32_bf16 v[44:47], a[224:227], v[112:115], v[44:47]
    ds_read_b64_tr_b16 a[236:237], v19 offset:6336
    v_mfma_f32_16x16x32_bf16 v[48:51], a[216:219], v[116:119], v[48:51]
    ds_read_b64_tr_b16 a[238:239], v19 offset:7104
    v_mfma_f32_16x16x32_bf16 v[52:55], a[220:223], v[116:119], v[52:55]
    ds_read_b128 v[128:131], v16 offset:17984
    v_mfma_f32_16x16x32_bf16 v[56:59], a[224:227], v[116:119], v[56:59]
    ds_read_b128 v[132:135], v16 offset:26944
    s_waitcnt lgkmcnt(8)
    v_mfma_f32_16x16x32_bf16 v[60:63], a[216:219], v[120:123], v[60:63]
    ds_read_b128 v[136:139], v16 offset:35904
    v_mfma_f32_16x16x32_bf16 v[64:67], a[220:223], v[120:123], v[64:67]
    ds_read_b128 v[140:143], v16 offset:44864
    v_mfma_f32_16x16x32_bf16 v[68:71], a[224:227], v[120:123], v[68:71]
    ds_read_b128 v[144:147], v16 offset:53824
    v_mfma_f32_16x16x32_bf16 v[72:75], a[216:219], v[124:127], v[72:75]
    v_mfma_f32_16x16x32_bf16 v[76:79], a[220:223], v[124:127], v[76:79]
    s_add_u32 m0, s42, 81664
    s_nop 0
    buffer_load_dwordx4 v245, s[16:19], s44 offen lds
    v_mfma_f32_16x16x32_bf16 v[80:83], a[224:227], v[124:127], v[80:83]
    s_waitcnt lgkmcnt(2)
    v_mfma_f32_16x16x32_bf16 v[24:27], a[228:231], v[128:131], v[24:27]
    ds_read_b64_tr_b16 a[240:241], v19 offset:12544
    v_mfma_f32_16x16x32_bf16 v[28:31], a[232:235], v[128:131], v[28:31]
    ds_read_b64_tr_b16 a[242:243], v19 offset:13312
    v_mfma_f32_16x16x32_bf16 v[32:35], a[236:239], v[128:131], v[32:35]
    ds_read_b64_tr_b16 a[244:245], v19 offset:12576
    v_mfma_f32_16x16x32_bf16 v[36:39], a[228:231], v[132:135], v[36:39]
    ds_read_b64_tr_b16 a[246:247], v19 offset:13344
    v_mfma_f32_16x16x32_bf16 v[40:43], a[232:235], v[132:135], v[40:43]
    ds_read_b64_tr_b16 a[248:249], v19 offset:12608
    v_mfma_f32_16x16x32_bf16 v[44:47], a[236:239], v[132:135], v[44:47]
    ds_read_b64_tr_b16 a[250:251], v19 offset:13376
    v_mfma_f32_16x16x32_bf16 v[48:51], a[228:231], v[136:139], v[48:51]
    ds_read_b128 v[108:111], v16 offset:18048
    v_mfma_f32_16x16x32_bf16 v[52:55], a[232:235], v[136:139], v[52:55]
    s_add_u32 m0, s42, 82688
    s_nop 0
    buffer_load_dwordx4 v246, s[16:19], s44 offen lds
    v_mfma_f32_16x16x32_bf16 v[56:59], a[236:239], v[136:139], v[56:59]
    ds_read_b128 v[112:115], v16 offset:27008
    s_waitcnt lgkmcnt(8)
    v_mfma_f32_16x16x32_bf16 v[60:63], a[228:231], v[140:143], v[60:63]
    ds_read_b128 v[116:119], v16 offset:35968
    v_mfma_f32_16x16x32_bf16 v[64:67], a[232:235], v[140:143], v[64:67]
    ds_read_b128 v[120:123], v16 offset:44928
    v_mfma_f32_16x16x32_bf16 v[68:71], a[236:239], v[140:143], v[68:71]
    ds_read_b128 v[124:127], v16 offset:53888
    v_mfma_f32_16x16x32_bf16 v[72:75], a[228:231], v[144:147], v[72:75]
    v_mfma_f32_16x16x32_bf16 v[76:79], a[232:235], v[144:147], v[76:79]
    v_mfma_f32_16x16x32_bf16 v[80:83], a[236:239], v[144:147], v[80:83]
    s_waitcnt lgkmcnt(5)
    s_waitcnt vmcnt(3)
    s_barrier
    s_waitcnt lgkmcnt(2)
    v_mfma_f32_16x16x32_bf16 v[24:27], a[240:243], v[108:111], v[24:27]
    ds_read_b64_tr_b16 a[252:253], v19 offset:19456
    v_mfma_f32_16x16x32_bf16 v[28:31], a[244:247], v[108:111], v[28:31]
    s_add_u32 m0, s42, 83712
    s_nop 0
    buffer_load_dwordx4 v247, s[16:19], s44 offen lds
    v_mfma_f32_16x16x32_bf16 v[32:35], a[248:251], v[108:111], v[32:35]
    ds_read_b64_tr_b16 a[254:255], v19 offset:20224
    v_mfma_f32_16x16x32_bf16 v[36:39], a[240:243], v[112:115], v[36:39]
    ds_read_b64_tr_b16 v[176:177], v19 offset:19488
    v_mfma_f32_16x16x32_bf16 v[40:43], a[244:247], v[112:115], v[40:43]
    ds_read_b64_tr_b16 v[178:179], v19 offset:20256
    v_mfma_f32_16x16x32_bf16 v[44:47], a[248:251], v[112:115], v[44:47]
    ds_read_b64_tr_b16 v[180:181], v19 offset:19520
    v_mfma_f32_16x16x32_bf16 v[48:51], a[240:243], v[116:119], v[48:51]
    ds_read_b64_tr_b16 v[182:183], v19 offset:20288
    v_mfma_f32_16x16x32_bf16 v[52:55], a[244:247], v[116:119], v[52:55]
    ds_read_b128 v[128:131], v16 offset:18368
    v_mfma_f32_16x16x32_bf16 v[56:59], a[248:251], v[116:119], v[56:59]
    ds_read_b128 v[132:135], v16 offset:27328
    s_waitcnt lgkmcnt(8)
    v_mfma_f32_16x16x32_bf16 v[60:63], a[240:243], v[120:123], v[60:63]
    ds_read_b128 v[136:139], v16 offset:36288
    v_mfma_f32_16x16x32_bf16 v[64:67], a[244:247], v[120:123], v[64:67]
    s_add_u32 m0, s76, 80640
    s_nop 0
    buffer_load_dwordx4 v248, s[16:19], s44 offen lds
    v_mfma_f32_16x16x32_bf16 v[68:71], a[248:251], v[120:123], v[68:71]
    ds_read_b128 v[140:143], v16 offset:45248
    v_mfma_f32_16x16x32_bf16 v[72:75], a[240:243], v[124:127], v[72:75]
    ds_read_b128 v[144:147], v16 offset:54208
    v_mfma_f32_16x16x32_bf16 v[76:79], a[244:247], v[124:127], v[76:79]
    v_mfma_f32_16x16x32_bf16 v[80:83], a[248:251], v[124:127], v[80:83]
    s_waitcnt lgkmcnt(2)
    v_mfma_f32_16x16x32_bf16 v[24:27], a[252:255], v[128:131], v[24:27]
    ds_read_b64_tr_b16 v[184:185], v19 offset:25728
    v_mfma_f32_16x16x32_bf16 v[28:31], v[176:179], v[128:131], v[28:31]
    ds_read_b64_tr_b16 v[186:187], v19 offset:26496
    v_mfma_f32_16x16x32_bf16 v[32:35], v[180:183], v[128:131], v[32:35]
    ds_read_b64_tr_b16 v[188:189], v19 offset:25760
    v_mfma_f32_16x16x32_bf16 v[36:39], a[252:255], v[132:135], v[36:39]
    ds_read_b64_tr_b16 v[190:191], v19 offset:26528
    v_mfma_f32_16x16x32_bf16 v[40:43], v[176:179], v[132:135], v[40:43]
    ds_read_b64_tr_b16 v[192:193], v19 offset:25792
    v_mfma_f32_16x16x32_bf16 v[44:47], v[180:183], v[132:135], v[44:47]
    ds_read_b64_tr_b16 v[194:195], v19 offset:26560
    v_mfma_f32_16x16x32_bf16 v[48:51], a[252:255], v[136:139], v[48:51]
    ds_read_b128 v[108:111], v16 offset:18432
    v_mfma_f32_16x16x32_bf16 v[52:55], v[176:179], v[136:139], v[52:55]
    ds_read_b128 v[112:115], v16 offset:27392
    v_mfma_f32_16x16x32_bf16 v[56:59], v[180:183], v[136:139], v[56:59]
    ds_read_b128 v[116:119], v16 offset:36352
    s_waitcnt lgkmcnt(9)
    v_mfma_f32_16x16x32_bf16 v[60:63], a[252:255], v[140:143], v[60:63]
    ds_read_b128 v[120:123], v16 offset:45312
    v_mfma_f32_16x16x32_bf16 v[64:67], v[176:179], v[140:143], v[64:67]
    ds_read_b128 v[124:127], v16 offset:54272
    v_mfma_f32_16x16x32_bf16 v[68:71], v[180:183], v[140:143], v[68:71]
    v_mfma_f32_16x16x32_bf16 v[72:75], a[252:255], v[144:147], v[72:75]
    v_mfma_f32_16x16x32_bf16 v[76:79], v[176:179], v[144:147], v[76:79]
    v_mfma_f32_16x16x32_bf16 v[80:83], v[180:183], v[144:147], v[80:83]
    s_waitcnt lgkmcnt(2)
    v_mfma_f32_16x16x32_bf16 v[24:27], v[184:187], v[108:111], v[24:27]
    ds_read_b64_tr_b16 v[196:197], v19 offset:32000
    v_mfma_f32_16x16x32_bf16 v[28:31], v[188:191], v[108:111], v[28:31]
    ds_read_b64_tr_b16 v[198:199], v19 offset:32768
    v_mfma_f32_16x16x32_bf16 v[32:35], v[192:195], v[108:111], v[32:35]
    ds_read_b64_tr_b16 v[200:201], v19 offset:32032
    v_mfma_f32_16x16x32_bf16 v[36:39], v[184:187], v[112:115], v[36:39]
    ds_read_b64_tr_b16 v[202:203], v19 offset:32800
    v_mfma_f32_16x16x32_bf16 v[40:43], v[188:191], v[112:115], v[40:43]
    ds_read_b64_tr_b16 v[204:205], v19 offset:32064
    v_mfma_f32_16x16x32_bf16 v[44:47], v[192:195], v[112:115], v[44:47]
    ds_read_b64_tr_b16 v[206:207], v19 offset:32832
    v_mfma_f32_16x16x32_bf16 v[48:51], v[184:187], v[116:119], v[48:51]
    ds_read_b128 v[128:131], v16 offset:18496
    v_mfma_f32_16x16x32_bf16 v[52:55], v[188:191], v[116:119], v[52:55]
    ds_read_b128 v[132:135], v16 offset:27456
    v_mfma_f32_16x16x32_bf16 v[56:59], v[192:195], v[116:119], v[56:59]
    ds_read_b128 v[136:139], v16 offset:36416
    s_waitcnt lgkmcnt(9)
    v_mfma_f32_16x16x32_bf16 v[60:63], v[184:187], v[120:123], v[60:63]
    ds_read_b128 v[140:143], v16 offset:45376
    v_mfma_f32_16x16x32_bf16 v[64:67], v[188:191], v[120:123], v[64:67]
    ds_read_b128 v[144:147], v16 offset:54336
    v_mfma_f32_16x16x32_bf16 v[68:71], v[192:195], v[120:123], v[68:71]
    v_mfma_f32_16x16x32_bf16 v[72:75], v[184:187], v[124:127], v[72:75]
    v_mfma_f32_16x16x32_bf16 v[76:79], v[188:191], v[124:127], v[76:79]
    v_mfma_f32_16x16x32_bf16 v[80:83], v[192:195], v[124:127], v[80:83]
    s_waitcnt lgkmcnt(5)
    s_waitcnt vmcnt(0)
    s_barrier
    s_waitcnt lgkmcnt(2)
    v_mfma_f32_16x16x32_bf16 v[24:27], v[196:199], v[128:131], v[24:27]
    ds_read_b64_tr_b16 v[208:209], v18 offset:0
    v_mfma_f32_16x16x32_bf16 v[28:31], v[200:203], v[128:131], v[28:31]
    ds_read_b64_tr_b16 v[210:211], v18 offset:768
    v_mfma_f32_16x16x32_bf16 v[32:35], v[204:207], v[128:131], v[32:35]
    ds_read_b64_tr_b16 v[212:213], v18 offset:32
    v_mfma_f32_16x16x32_bf16 v[36:39], v[196:199], v[132:135], v[36:39]
    ds_read_b64_tr_b16 v[214:215], v18 offset:800
    v_mfma_f32_16x16x32_bf16 v[40:43], v[200:203], v[132:135], v[40:43]
    ds_read_b64_tr_b16 v[216:217], v18 offset:64
    v_mfma_f32_16x16x32_bf16 v[44:47], v[204:207], v[132:135], v[44:47]
    ds_read_b64_tr_b16 v[218:219], v18 offset:832
    v_mfma_f32_16x16x32_bf16 v[48:51], v[196:199], v[136:139], v[48:51]
    ds_read_b128 v[108:111], v16 offset:18816
    v_mfma_f32_16x16x32_bf16 v[52:55], v[200:203], v[136:139], v[52:55]
    ds_read_b128 v[112:115], v16 offset:27776
    v_mfma_f32_16x16x32_bf16 v[56:59], v[204:207], v[136:139], v[56:59]
    ds_read_b128 v[116:119], v16 offset:36736
    s_waitcnt lgkmcnt(9)
    v_mfma_f32_16x16x32_bf16 v[60:63], v[196:199], v[140:143], v[60:63]
    ds_read_b128 v[120:123], v16 offset:45696
    v_mfma_f32_16x16x32_bf16 v[64:67], v[200:203], v[140:143], v[64:67]
    ds_read_b128 v[124:127], v16 offset:54656
    v_mfma_f32_16x16x32_bf16 v[68:71], v[204:207], v[140:143], v[68:71]
    v_mfma_f32_16x16x32_bf16 v[72:75], v[196:199], v[144:147], v[72:75]
    v_mfma_f32_16x16x32_bf16 v[76:79], v[200:203], v[144:147], v[76:79]
    v_mfma_f32_16x16x32_bf16 v[80:83], v[204:207], v[144:147], v[80:83]
    s_waitcnt lgkmcnt(2)
    v_mfma_f32_16x16x32_bf16 v[24:27], v[208:211], v[108:111], v[24:27]
    ds_read_b64_tr_b16 v[220:221], v18 offset:6272
    v_mfma_f32_16x16x32_bf16 v[28:31], v[212:215], v[108:111], v[28:31]
    ds_read_b64_tr_b16 v[222:223], v18 offset:7040
    v_mfma_f32_16x16x32_bf16 v[32:35], v[216:219], v[108:111], v[32:35]
    ds_read_b64_tr_b16 v[224:225], v18 offset:6304
    v_mfma_f32_16x16x32_bf16 v[36:39], v[208:211], v[112:115], v[36:39]
    ds_read_b64_tr_b16 v[226:227], v18 offset:7072
    v_mfma_f32_16x16x32_bf16 v[40:43], v[212:215], v[112:115], v[40:43]
    ds_read_b64_tr_b16 v[228:229], v18 offset:6336
    v_mfma_f32_16x16x32_bf16 v[44:47], v[216:219], v[112:115], v[44:47]
    ds_read_b64_tr_b16 v[230:231], v18 offset:7104
    v_mfma_f32_16x16x32_bf16 v[48:51], v[208:211], v[116:119], v[48:51]
    ds_read_b128 v[128:131], v16 offset:18880
    v_mfma_f32_16x16x32_bf16 v[52:55], v[212:215], v[116:119], v[52:55]
    ds_read_b128 v[132:135], v16 offset:27840
    v_mfma_f32_16x16x32_bf16 v[56:59], v[216:219], v[116:119], v[56:59]
    ds_read_b128 v[136:139], v16 offset:36800
    s_waitcnt lgkmcnt(9)
    v_mfma_f32_16x16x32_bf16 v[60:63], v[208:211], v[120:123], v[60:63]
    ds_read_b128 v[140:143], v16 offset:45760
    v_mfma_f32_16x16x32_bf16 v[64:67], v[212:215], v[120:123], v[64:67]
    ds_read_b128 v[144:147], v16 offset:54720
    v_mfma_f32_16x16x32_bf16 v[68:71], v[216:219], v[120:123], v[68:71]
    v_mfma_f32_16x16x32_bf16 v[72:75], v[208:211], v[124:127], v[72:75]
    v_mfma_f32_16x16x32_bf16 v[76:79], v[212:215], v[124:127], v[76:79]
    v_mfma_f32_16x16x32_bf16 v[80:83], v[216:219], v[124:127], v[80:83]
    s_waitcnt lgkmcnt(2)
    v_mfma_f32_16x16x32_bf16 v[24:27], v[220:223], v[128:131], v[24:27]
    ds_read_b64_tr_b16 v[232:233], v18 offset:12544
    v_mfma_f32_16x16x32_bf16 v[28:31], v[224:227], v[128:131], v[28:31]
    ds_read_b64_tr_b16 v[234:235], v18 offset:13312
    v_mfma_f32_16x16x32_bf16 v[32:35], v[228:231], v[128:131], v[32:35]
    ds_read_b64_tr_b16 v[236:237], v18 offset:12576
    v_mfma_f32_16x16x32_bf16 v[36:39], v[220:223], v[132:135], v[36:39]
    ds_read_b64_tr_b16 v[238:239], v18 offset:13344
    v_mfma_f32_16x16x32_bf16 v[40:43], v[224:227], v[132:135], v[40:43]
    ds_read_b64_tr_b16 v[240:241], v18 offset:12608
    v_mfma_f32_16x16x32_bf16 v[44:47], v[228:231], v[132:135], v[44:47]
    ds_read_b64_tr_b16 v[242:243], v18 offset:13376
    v_mfma_f32_16x16x32_bf16 v[48:51], v[220:223], v[136:139], v[48:51]
    ds_read_b128 v[108:111], v16 offset:18944
    v_mfma_f32_16x16x32_bf16 v[52:55], v[224:227], v[136:139], v[52:55]
    ds_read_b128 v[112:115], v16 offset:27904
    v_mfma_f32_16x16x32_bf16 v[56:59], v[228:231], v[136:139], v[56:59]
    ds_read_b128 v[116:119], v16 offset:36864
    s_waitcnt lgkmcnt(9)
    v_mfma_f32_16x16x32_bf16 v[60:63], v[220:223], v[140:143], v[60:63]
    ds_read_b128 v[120:123], v16 offset:45824
    v_mfma_f32_16x16x32_bf16 v[64:67], v[224:227], v[140:143], v[64:67]
    ds_read_b128 v[124:127], v16 offset:54784
    v_mfma_f32_16x16x32_bf16 v[68:71], v[228:231], v[140:143], v[68:71]
    v_mfma_f32_16x16x32_bf16 v[72:75], v[220:223], v[144:147], v[72:75]
    v_mfma_f32_16x16x32_bf16 v[76:79], v[224:227], v[144:147], v[76:79]
    v_mfma_f32_16x16x32_bf16 v[80:83], v[228:231], v[144:147], v[80:83]
    s_waitcnt lgkmcnt(2)
    v_mfma_f32_16x16x32_bf16 v[24:27], v[232:235], v[108:111], v[24:27]
    ds_read_b128 v[128:131], v17 offset:0
    v_mfma_f32_16x16x32_bf16 v[28:31], v[236:239], v[108:111], v[28:31]
    ds_read_b128 v[132:135], v17 offset:64
    v_mfma_f32_16x16x32_bf16 v[32:35], v[240:243], v[108:111], v[32:35]
    ds_read_b128 v[136:139], v17 offset:128
    v_mfma_f32_16x16x32_bf16 v[36:39], v[232:235], v[112:115], v[36:39]
    ds_read_b128 v[140:143], v17 offset:448
    v_mfma_f32_16x16x32_bf16 v[40:43], v[236:239], v[112:115], v[40:43]
    ds_read_b128 v[144:147], v17 offset:512
    v_mfma_f32_16x16x32_bf16 v[44:47], v[240:243], v[112:115], v[44:47]
    ds_read_b128 v[148:151], v17 offset:576
    v_mfma_f32_16x16x32_bf16 v[48:51], v[232:235], v[116:119], v[48:51]
    v_mfma_f32_16x16x32_bf16 v[52:55], v[236:239], v[116:119], v[52:55]
    v_mfma_f32_16x16x32_bf16 v[56:59], v[240:243], v[116:119], v[56:59]
    s_waitcnt lgkmcnt(6)
    v_mfma_f32_16x16x32_bf16 v[60:63], v[232:235], v[120:123], v[60:63]
    v_mfma_f32_16x16x32_bf16 v[64:67], v[236:239], v[120:123], v[64:67]
    v_mfma_f32_16x16x32_bf16 v[68:71], v[240:243], v[120:123], v[68:71]
    v_mfma_f32_16x16x32_bf16 v[72:75], v[232:235], v[124:127], v[72:75]
    v_mfma_f32_16x16x32_bf16 v[76:79], v[236:239], v[124:127], v[76:79]
    v_mfma_f32_16x16x32_bf16 v[80:83], v[240:243], v[124:127], v[80:83]
    s_waitcnt lgkmcnt(5)
    v_mfma_f32_16x16x32_bf16 v[84:87], a[0:3], v[128:131], 0
    ds_read_b128 v[108:111], v17 offset:896
    v_mfma_f32_16x16x32_bf16 v[88:91], a[4:7], v[128:131], 0
    ds_read_b128 v[112:115], v17 offset:960
    v_mfma_f32_16x16x32_bf16 v[92:95], a[8:11], v[128:131], 0
    ds_read_b128 v[116:119], v17 offset:1024
    s_waitcnt lgkmcnt(7)
    v_mfma_f32_16x16x32_bf16 v[84:87], a[12:15], v[132:135], v[84:87]
    v_mfma_f32_16x16x32_bf16 v[88:91], a[16:19], v[132:135], v[88:91]
    v_mfma_f32_16x16x32_bf16 v[92:95], a[20:23], v[132:135], v[92:95]
    s_waitcnt lgkmcnt(6)
    v_mfma_f32_16x16x32_bf16 v[84:87], a[24:27], v[136:139], v[84:87]
    v_mfma_f32_16x16x32_bf16 v[88:91], a[28:31], v[136:139], v[88:91]
    v_mfma_f32_16x16x32_bf16 v[92:95], a[32:35], v[136:139], v[92:95]
    s_waitcnt lgkmcnt(5)
    v_mfma_f32_16x16x32_bf16 v[84:87], a[36:39], v[140:143], v[84:87]
    ds_read_b128 v[128:131], v17 offset:8960
    v_cvt_pk_bf16_f32 v152, v24, v25
    v_mfma_f32_16x16x32_bf16 v[88:91], a[40:43], v[140:143], v[88:91]
    ds_read_b128 v[132:135], v17 offset:9024
    v_cvt_pk_bf16_f32 v153, v26, v27
    v_mfma_f32_16x16x32_bf16 v[92:95], a[44:47], v[140:143], v[92:95]
    ds_read_b128 v[136:139], v17 offset:9088
    v_cvt_pk_bf16_f32 v154, v28, v29
    s_waitcnt lgkmcnt(7)
    v_mfma_f32_16x16x32_bf16 v[84:87], a[48:51], v[144:147], v[84:87]
    v_cvt_pk_bf16_f32 v155, v30, v31
    v_mfma_f32_16x16x32_bf16 v[88:91], a[52:55], v[144:147], v[88:91]
    v_cvt_pk_bf16_f32 v156, v32, v33
    v_mfma_f32_16x16x32_bf16 v[92:95], a[56:59], v[144:147], v[92:95]
    v_cvt_pk_bf16_f32 v157, v34, v35
    s_waitcnt lgkmcnt(6)
    v_mfma_f32_16x16x32_bf16 v[84:87], a[60:63], v[148:151], v[84:87]
    s_add_u32 s48, s47, 0
    v_mfma_f32_16x16x32_bf16 v[88:91], a[64:67], v[148:151], v[88:91]
    v_permlane16_swap_b32 v152, v154
    v_mfma_f32_16x16x32_bf16 v[92:95], a[68:71], v[148:151], v[92:95]
    v_permlane16_swap_b32 v153, v155
    s_waitcnt lgkmcnt(5)
    v_mfma_f32_16x16x32_bf16 v[84:87], a[72:75], v[108:111], v[84:87]
    ds_read_b128 v[140:143], v17 offset:9408
    buffer_store_dwordx2 v[156:157], v21, s[20:23], s48 offen
    v_mfma_f32_16x16x32_bf16 v[88:91], a[76:79], v[108:111], v[88:91]
    ds_read_b128 v[144:147], v17 offset:9472
    v_mfma_f32_16x16x32_bf16 v[92:95], a[80:83], v[108:111], v[92:95]
    ds_read_b128 v[148:151], v17 offset:9536
    s_waitcnt lgkmcnt(7)
    v_mfma_f32_16x16x32_bf16 v[84:87], a[84:87], v[112:115], v[84:87]
    v_mfma_f32_16x16x32_bf16 v[88:91], a[88:91], v[112:115], v[88:91]
    buffer_store_dwordx4 v[152:155], v20, s[20:23], s48 offen
    v_mfma_f32_16x16x32_bf16 v[92:95], a[92:95], v[112:115], v[92:95]
    s_waitcnt lgkmcnt(6)
    v_mfma_f32_16x16x32_bf16 v[84:87], a[96:99], v[116:119], v[84:87]
    v_mfma_f32_16x16x32_bf16 v[88:91], a[100:103], v[116:119], v[88:91]
    v_mfma_f32_16x16x32_bf16 v[92:95], a[104:107], v[116:119], v[92:95]
    v_cvt_pk_bf16_f32 v160, v36, v37
    s_waitcnt lgkmcnt(5)
    v_mfma_f32_16x16x32_bf16 v[84:87], a[108:111], v[128:131], v[84:87]
    ds_read_b128 v[108:111], v17 offset:9856
    v_cvt_pk_bf16_f32 v161, v38, v39
    v_mfma_f32_16x16x32_bf16 v[88:91], a[112:115], v[128:131], v[88:91]
    ds_read_b128 v[112:115], v17 offset:9920
    v_cvt_pk_bf16_f32 v162, v40, v41
    v_mfma_f32_16x16x32_bf16 v[92:95], a[116:119], v[128:131], v[92:95]
    ds_read_b128 v[116:119], v17 offset:9984
    v_cvt_pk_bf16_f32 v163, v42, v43
    s_waitcnt lgkmcnt(7)
    v_mfma_f32_16x16x32_bf16 v[84:87], a[120:123], v[132:135], v[84:87]
    v_cvt_pk_bf16_f32 v164, v44, v45
    v_mfma_f32_16x16x32_bf16 v[88:91], a[124:127], v[132:135], v[88:91]
    v_cvt_pk_bf16_f32 v165, v46, v47
    v_mfma_f32_16x16x32_bf16 v[92:95], a[128:131], v[132:135], v[92:95]
    s_add_u32 s48, s47, 86016
    s_waitcnt lgkmcnt(6)
    v_mfma_f32_16x16x32_bf16 v[84:87], a[132:135], v[136:139], v[84:87]
    v_permlane16_swap_b32 v160, v162
    v_mfma_f32_16x16x32_bf16 v[88:91], a[136:139], v[136:139], v[88:91]
    v_permlane16_swap_b32 v161, v163
    v_mfma_f32_16x16x32_bf16 v[92:95], a[140:143], v[136:139], v[92:95]
    buffer_store_dwordx2 v[164:165], v21, s[20:23], s48 offen
    s_waitcnt lgkmcnt(5)
    v_mfma_f32_16x16x32_bf16 v[84:87], a[144:147], v[140:143], v[84:87]
    ds_read_b128 v[128:131], v17 offset:17920
    v_mfma_f32_16x16x32_bf16 v[88:91], a[148:151], v[140:143], v[88:91]
    ds_read_b128 v[132:135], v17 offset:17984
    v_mfma_f32_16x16x32_bf16 v[92:95], a[152:155], v[140:143], v[92:95]
    ds_read_b128 v[136:139], v17 offset:18048
    s_waitcnt lgkmcnt(7)
    v_mfma_f32_16x16x32_bf16 v[84:87], a[156:159], v[144:147], v[84:87]
    buffer_store_dwordx4 v[160:163], v20, s[20:23], s48 offen
    v_mfma_f32_16x16x32_bf16 v[88:91], a[160:163], v[144:147], v[88:91]
    v_mfma_f32_16x16x32_bf16 v[92:95], a[164:167], v[144:147], v[92:95]
    s_waitcnt lgkmcnt(6)
    v_mfma_f32_16x16x32_bf16 v[84:87], a[168:171], v[148:151], v[84:87]
    v_mfma_f32_16x16x32_bf16 v[88:91], a[172:175], v[148:151], v[88:91]
    v_cvt_pk_bf16_f32 v168, v48, v49
    v_mfma_f32_16x16x32_bf16 v[92:95], a[176:179], v[148:151], v[92:95]
    v_cvt_pk_bf16_f32 v169, v50, v51
    s_waitcnt lgkmcnt(5)
    v_mfma_f32_16x16x32_bf16 v[84:87], a[180:183], v[108:111], v[84:87]
    ds_read_b128 v[140:143], v17 offset:18368
    v_cvt_pk_bf16_f32 v170, v52, v53
    v_mfma_f32_16x16x32_bf16 v[88:91], a[184:187], v[108:111], v[88:91]
    ds_read_b128 v[144:147], v17 offset:18432
    v_cvt_pk_bf16_f32 v171, v54, v55
    v_mfma_f32_16x16x32_bf16 v[92:95], a[188:191], v[108:111], v[92:95]
    ds_read_b128 v[148:151], v17 offset:18496
    v_cvt_pk_bf16_f32 v172, v56, v57
    s_waitcnt lgkmcnt(7)
    v_mfma_f32_16x16x32_bf16 v[84:87], a[192:195], v[112:115], v[84:87]
    v_cvt_pk_bf16_f32 v173, v58, v59
    v_mfma_f32_16x16x32_bf16 v[88:91], a[196:199], v[112:115], v[88:91]
    s_add_u32 s48, s47, 172032
    v_mfma_f32_16x16x32_bf16 v[92:95], a[200:203], v[112:115], v[92:95]
    v_permlane16_swap_b32 v168, v170
    s_waitcnt lgkmcnt(6)
    v_mfma_f32_16x16x32_bf16 v[84:87], a[204:207], v[116:119], v[84:87]
    v_permlane16_swap_b32 v169, v171
    v_mfma_f32_16x16x32_bf16 v[88:91], a[208:211], v[116:119], v[88:91]
    buffer_store_dwordx2 v[172:173], v21, s[20:23], s48 offen
    v_mfma_f32_16x16x32_bf16 v[92:95], a[212:215], v[116:119], v[92:95]
    s_waitcnt lgkmcnt(5)
    v_mfma_f32_16x16x32_bf16 v[84:87], a[216:219], v[128:131], v[84:87]
    ds_read_b128 v[108:111], v17 offset:18816
    v_mfma_f32_16x16x32_bf16 v[88:91], a[220:223], v[128:131], v[88:91]
    ds_read_b128 v[112:115], v17 offset:18880
    v_mfma_f32_16x16x32_bf16 v[92:95], a[224:227], v[128:131], v[92:95]
    ds_read_b128 v[116:119], v17 offset:18944
    buffer_store_dwordx4 v[168:171], v20, s[20:23], s48 offen
    s_waitcnt lgkmcnt(7)
    v_mfma_f32_16x16x32_bf16 v[84:87], a[228:231], v[132:135], v[84:87]
    v_mfma_f32_16x16x32_bf16 v[88:91], a[232:235], v[132:135], v[88:91]
    v_mfma_f32_16x16x32_bf16 v[92:95], a[236:239], v[132:135], v[92:95]
    s_waitcnt lgkmcnt(6)
    v_mfma_f32_16x16x32_bf16 v[84:87], a[240:243], v[136:139], v[84:87]
    v_cvt_pk_bf16_f32 v152, v60, v61
    v_mfma_f32_16x16x32_bf16 v[88:91], a[244:247], v[136:139], v[88:91]
    v_cvt_pk_bf16_f32 v153, v62, v63
    v_mfma_f32_16x16x32_bf16 v[92:95], a[248:251], v[136:139], v[92:95]
    v_cvt_pk_bf16_f32 v154, v64, v65
    s_waitcnt lgkmcnt(5)
    v_mfma_f32_16x16x32_bf16 v[84:87], a[252:255], v[140:143], v[84:87]
    ds_read_b128 v[128:131], v17 offset:8960
    v_cvt_pk_bf16_f32 v155, v66, v67
    v_mfma_f32_16x16x32_bf16 v[88:91], v[176:179], v[140:143], v[88:91]
    ds_read_b128 v[132:135], v17 offset:9024
    v_cvt_pk_bf16_f32 v156, v68, v69
    v_mfma_f32_16x16x32_bf16 v[92:95], v[180:183], v[140:143], v[92:95]
    ds_read_b128 v[136:139], v17 offset:9088
    v_cvt_pk_bf16_f32 v157, v70, v71
    s_waitcnt lgkmcnt(7)
    v_mfma_f32_16x16x32_bf16 v[84:87], v[184:187], v[144:147], v[84:87]
    s_add_u32 s48, s47, 258048
    v_mfma_f32_16x16x32_bf16 v[88:91], v[188:191], v[144:147], v[88:91]
    v_permlane16_swap_b32 v152, v154
    v_mfma_f32_16x16x32_bf16 v[92:95], v[192:195], v[144:147], v[92:95]
    v_permlane16_swap_b32 v153, v155
    s_waitcnt lgkmcnt(6)
    v_mfma_f32_16x16x32_bf16 v[84:87], v[196:199], v[148:151], v[84:87]
    buffer_store_dwordx2 v[156:157], v21, s[20:23], s48 offen
    v_mfma_f32_16x16x32_bf16 v[88:91], v[200:203], v[148:151], v[88:91]
    v_mfma_f32_16x16x32_bf16 v[92:95], v[204:207], v[148:151], v[92:95]
    s_waitcnt lgkmcnt(5)
    v_mfma_f32_16x16x32_bf16 v[84:87], v[208:211], v[108:111], v[84:87]
    ds_read_b128 v[140:143], v17 offset:9408
    v_mfma_f32_16x16x32_bf16 v[88:91], v[212:215], v[108:111], v[88:91]
    ds_read_b128 v[144:147], v17 offset:9472
    buffer_store_dwordx4 v[152:155], v20, s[20:23], s48 offen
    v_mfma_f32_16x16x32_bf16 v[92:95], v[216:219], v[108:111], v[92:95]
    ds_read_b128 v[148:151], v17 offset:9536
    s_waitcnt lgkmcnt(7)
    v_mfma_f32_16x16x32_bf16 v[84:87], v[220:223], v[112:115], v[84:87]
    v_mfma_f32_16x16x32_bf16 v[88:91], v[224:227], v[112:115], v[88:91]
    v_mfma_f32_16x16x32_bf16 v[92:95], v[228:231], v[112:115], v[92:95]
    v_cvt_pk_bf16_f32 v160, v72, v73
    s_waitcnt lgkmcnt(6)
    v_mfma_f32_16x16x32_bf16 v[84:87], v[232:235], v[116:119], v[84:87]
    v_cvt_pk_bf16_f32 v161, v74, v75
    v_mfma_f32_16x16x32_bf16 v[88:91], v[236:239], v[116:119], v[88:91]
    v_cvt_pk_bf16_f32 v162, v76, v77
    v_mfma_f32_16x16x32_bf16 v[92:95], v[240:243], v[116:119], v[92:95]
    v_cvt_pk_bf16_f32 v163, v78, v79
    s_waitcnt lgkmcnt(5)
    v_mfma_f32_16x16x32_bf16 v[96:99], a[0:3], v[128:131], 0
    ds_read_b128 v[108:111], v17 offset:9856
    v_mfma_f32_16x16x32_bf16 v[100:103], a[4:7], v[128:131], 0
    ds_read_b128 v[112:115], v17 offset:9920
    v_mfma_f32_16x16x32_bf16 v[104:107], a[8:11], v[128:131], 0
    ds_read_b128 v[116:119], v17 offset:9984
    s_waitcnt lgkmcnt(7)
    v_mfma_f32_16x16x32_bf16 v[96:99], a[12:15], v[132:135], v[96:99]
    v_mfma_f32_16x16x32_bf16 v[100:103], a[16:19], v[132:135], v[100:103]
    v_mfma_f32_16x16x32_bf16 v[104:107], a[20:23], v[132:135], v[104:107]
    s_waitcnt lgkmcnt(6)
    v_mfma_f32_16x16x32_bf16 v[96:99], a[24:27], v[136:139], v[96:99]
    v_mfma_f32_16x16x32_bf16 v[100:103], a[28:31], v[136:139], v[100:103]
    v_mfma_f32_16x16x32_bf16 v[104:107], a[32:35], v[136:139], v[104:107]
    s_waitcnt lgkmcnt(5)
    v_mfma_f32_16x16x32_bf16 v[96:99], a[36:39], v[140:143], v[96:99]
    ds_read_b128 v[128:131], v17 offset:17920
    v_cvt_pk_bf16_f32 v164, v80, v81
    v_mfma_f32_16x16x32_bf16 v[100:103], a[40:43], v[140:143], v[100:103]
    ds_read_b128 v[132:135], v17 offset:17984
    v_cvt_pk_bf16_f32 v165, v82, v83
    v_mfma_f32_16x16x32_bf16 v[104:107], a[44:47], v[140:143], v[104:107]
    ds_read_b128 v[136:139], v17 offset:18048
    s_add_u32 s48, s47, 344064
    s_waitcnt lgkmcnt(7)
    v_mfma_f32_16x16x32_bf16 v[96:99], a[48:51], v[144:147], v[96:99]
    v_permlane16_swap_b32 v160, v162
    v_mfma_f32_16x16x32_bf16 v[100:103], a[52:55], v[144:147], v[100:103]
    v_permlane16_swap_b32 v161, v163
    v_mfma_f32_16x16x32_bf16 v[104:107], a[56:59], v[144:147], v[104:107]
    buffer_store_dwordx2 v[164:165], v21, s[20:23], s48 offen
    s_waitcnt lgkmcnt(6)
    v_mfma_f32_16x16x32_bf16 v[96:99], a[60:63], v[148:151], v[96:99]
    v_mfma_f32_16x16x32_bf16 v[100:103], a[64:67], v[148:151], v[100:103]
    v_mfma_f32_16x16x32_bf16 v[104:107], a[68:71], v[148:151], v[104:107]
    s_waitcnt lgkmcnt(5)
    v_mfma_f32_16x16x32_bf16 v[96:99], a[72:75], v[108:111], v[96:99]
    ds_read_b128 v[140:143], v17 offset:18368
    buffer_store_dwordx4 v[160:163], v20, s[20:23], s48 offen
    v_mfma_f32_16x16x32_bf16 v[100:103], a[76:79], v[108:111], v[100:103]
    ds_read_b128 v[144:147], v17 offset:18432
    v_mfma_f32_16x16x32_bf16 v[104:107], a[80:83], v[108:111], v[104:107]
    ds_read_b128 v[148:151], v17 offset:18496
    s_waitcnt lgkmcnt(7)
    v_mfma_f32_16x16x32_bf16 v[96:99], a[84:87], v[112:115], v[96:99]
    v_mfma_f32_16x16x32_bf16 v[100:103], a[88:91], v[112:115], v[100:103]
    v_cvt_pk_bf16_f32 v168, v84, v85
    v_mfma_f32_16x16x32_bf16 v[104:107], a[92:95], v[112:115], v[104:107]
    v_cvt_pk_bf16_f32 v169, v86, v87
    s_waitcnt lgkmcnt(6)
    v_mfma_f32_16x16x32_bf16 v[96:99], a[96:99], v[116:119], v[96:99]
    v_cvt_pk_bf16_f32 v170, v88, v89
    v_mfma_f32_16x16x32_bf16 v[100:103], a[100:103], v[116:119], v[100:103]
    v_cvt_pk_bf16_f32 v171, v90, v91
    v_mfma_f32_16x16x32_bf16 v[104:107], a[104:107], v[116:119], v[104:107]
    v_cvt_pk_bf16_f32 v172, v92, v93
    s_waitcnt lgkmcnt(5)
    v_mfma_f32_16x16x32_bf16 v[96:99], a[108:111], v[128:131], v[96:99]
    ds_read_b128 v[108:111], v17 offset:18816
    v_cvt_pk_bf16_f32 v173, v94, v95
    v_mfma_f32_16x16x32_bf16 v[100:103], a[112:115], v[128:131], v[100:103]
    ds_read_b128 v[112:115], v17 offset:18880
    s_add_u32 s48, s47, 430080
    v_mfma_f32_16x16x32_bf16 v[104:107], a[116:119], v[128:131], v[104:107]
    ds_read_b128 v[116:119], v17 offset:18944
    v_permlane16_swap_b32 v168, v170
    s_waitcnt lgkmcnt(7)
    v_mfma_f32_16x16x32_bf16 v[96:99], a[120:123], v[132:135], v[96:99]
    v_permlane16_swap_b32 v169, v171
    v_mfma_f32_16x16x32_bf16 v[100:103], a[124:127], v[132:135], v[100:103]
    buffer_store_dwordx2 v[172:173], v21, s[20:23], s48 offen
    v_mfma_f32_16x16x32_bf16 v[104:107], a[128:131], v[132:135], v[104:107]
    s_waitcnt lgkmcnt(6)
    v_mfma_f32_16x16x32_bf16 v[96:99], a[132:135], v[136:139], v[96:99]
    v_mfma_f32_16x16x32_bf16 v[100:103], a[136:139], v[136:139], v[100:103]
    v_mfma_f32_16x16x32_bf16 v[104:107], a[140:143], v[136:139], v[104:107]
    buffer_store_dwordx4 v[168:171], v20, s[20:23], s48 offen
    s_waitcnt lgkmcnt(5)
    v_mfma_f32_16x16x32_bf16 v[96:99], a[144:147], v[140:143], v[96:99]
    ds_read_b128 v[128:131], v17 offset:26880
    v_mfma_f32_16x16x32_bf16 v[100:103], a[148:151], v[140:143], v[100:103]
    ds_read_b128 v[132:135], v17 offset:26944
    v_mfma_f32_16x16x32_bf16 v[104:107], a[152:155], v[140:143], v[104:107]
    ds_read_b128 v[136:139], v17 offset:27008
    s_waitcnt lgkmcnt(7)
    v_mfma_f32_16x16x32_bf16 v[96:99], a[156:159], v[144:147], v[96:99]
    v_mfma_f32_16x16x32_bf16 v[100:103], a[160:163], v[144:147], v[100:103]
    v_mfma_f32_16x16x32_bf16 v[104:107], a[164:167], v[144:147], v[104:107]
    s_waitcnt lgkmcnt(6)
    v_mfma_f32_16x16x32_bf16 v[96:99], a[168:171], v[148:151], v[96:99]
    v_mfma_f32_16x16x32_bf16 v[100:103], a[172:175], v[148:151], v[100:103]
    v_mfma_f32_16x16x32_bf16 v[104:107], a[176:179], v[148:151], v[104:107]
    s_waitcnt lgkmcnt(5)
    v_mfma_f32_16x16x32_bf16 v[96:99], a[180:183], v[108:111], v[96:99]
    ds_read_b128 v[140:143], v17 offset:27328
    v_mfma_f32_16x16x32_bf16 v[100:103], a[184:187], v[108:111], v[100:103]
    ds_read_b128 v[144:147], v17 offset:27392
    v_mfma_f32_16x16x32_bf16 v[104:107], a[188:191], v[108:111], v[104:107]
    ds_read_b128 v[148:151], v17 offset:27456
    s_waitcnt lgkmcnt(7)
    v_mfma_f32_16x16x32_bf16 v[96:99], a[192:195], v[112:115], v[96:99]
    v_mfma_f32_16x16x32_bf16 v[100:103], a[196:199], v[112:115], v[100:103]
    v_mfma_f32_16x16x32_bf16 v[104:107], a[200:203], v[112:115], v[104:107]
    s_waitcnt lgkmcnt(6)
    v_mfma_f32_16x16x32_bf16 v[96:99], a[204:207], v[116:119], v[96:99]
    v_mfma_f32_16x16x32_bf16 v[100:103], a[208:211], v[116:119], v[100:103]
    v_mfma_f32_16x16x32_bf16 v[104:107], a[212:215], v[116:119], v[104:107]
    s_waitcnt lgkmcnt(5)
    v_mfma_f32_16x16x32_bf16 v[96:99], a[216:219], v[128:131], v[96:99]
    ds_read_b128 v[108:111], v17 offset:27776
    v_mfma_f32_16x16x32_bf16 v[100:103], a[220:223], v[128:131], v[100:103]
    ds_read_b128 v[112:115], v17 offset:27840
    v_mfma_f32_16x16x32_bf16 v[104:107], a[224:227], v[128:131], v[104:107]
    ds_read_b128 v[116:119], v17 offset:27904
    s_waitcnt lgkmcnt(7)
    v_mfma_f32_16x16x32_bf16 v[96:99], a[228:231], v[132:135], v[96:99]
    v_mfma_f32_16x16x32_bf16 v[100:103], a[232:235], v[132:135], v[100:103]
    v_mfma_f32_16x16x32_bf16 v[104:107], a[236:239], v[132:135], v[104:107]
    s_waitcnt lgkmcnt(6)
    v_mfma_f32_16x16x32_bf16 v[96:99], a[240:243], v[136:139], v[96:99]
    v_mfma_f32_16x16x32_bf16 v[100:103], a[244:247], v[136:139], v[100:103]
    v_mfma_f32_16x16x32_bf16 v[104:107], a[248:251], v[136:139], v[104:107]
    s_waitcnt lgkmcnt(5)
    v_mfma_f32_16x16x32_bf16 v[96:99], a[252:255], v[140:143], v[96:99]
    v_mfma_f32_16x16x32_bf16 v[100:103], v[176:179], v[140:143], v[100:103]
    v_mfma_f32_16x16x32_bf16 v[104:107], v[180:183], v[140:143], v[104:107]
    s_waitcnt lgkmcnt(4)
    v_mfma_f32_16x16x32_bf16 v[96:99], v[184:187], v[144:147], v[96:99]
    v_mfma_f32_16x16x32_bf16 v[100:103], v[188:191], v[144:147], v[100:103]
    v_mfma_f32_16x16x32_bf16 v[104:107], v[192:195], v[144:147], v[104:107]
    s_waitcnt lgkmcnt(3)
    v_mfma_f32_16x16x32_bf16 v[96:99], v[196:199], v[148:151], v[96:99]
    v_mfma_f32_16x16x32_bf16 v[100:103], v[200:203], v[148:151], v[100:103]
    v_mfma_f32_16x16x32_bf16 v[104:107], v[204:207], v[148:151], v[104:107]
    s_waitcnt lgkmcnt(2)
    v_mfma_f32_16x16x32_bf16 v[96:99], v[208:211], v[108:111], v[96:99]
    v_mfma_f32_16x16x32_bf16 v[100:103], v[212:215], v[108:111], v[100:103]
    v_mfma_f32_16x16x32_bf16 v[104:107], v[216:219], v[108:111], v[104:107]
    s_waitcnt lgkmcnt(1)
    v_mfma_f32_16x16x32_bf16 v[96:99], v[220:223], v[112:115], v[96:99]
    v_mfma_f32_16x16x32_bf16 v[100:103], v[224:227], v[112:115], v[100:103]
    v_mfma_f32_16x16x32_bf16 v[104:107], v[228:231], v[112:115], v[104:107]
    s_waitcnt lgkmcnt(0)
    v_mfma_f32_16x16x32_bf16 v[96:99], v[232:235], v[116:119], v[96:99]
    v_mfma_f32_16x16x32_bf16 v[100:103], v[236:239], v[116:119], v[100:103]
    v_mfma_f32_16x16x32_bf16 v[104:107], v[240:243], v[116:119], v[104:107]
    s_nop 7
    s_nop 1
    v_cvt_pk_bf16_f32 v152, v96, v97
    v_cvt_pk_bf16_f32 v153, v98, v99
    v_cvt_pk_bf16_f32 v154, v100, v101
    v_cvt_pk_bf16_f32 v155, v102, v103
    v_cvt_pk_bf16_f32 v156, v104, v105
    v_cvt_pk_bf16_f32 v157, v106, v107
    s_add_u32 s48, s47, 516096
    v_permlane16_swap_b32 v152, v154
    v_permlane16_swap_b32 v153, v155
    buffer_store_dwordx2 v[156:157], v21, s[20:23], s48 offen
    buffer_store_dwordx4 v[152:155], v20, s[20:23], s48 offen
L_end:
    s_endpgm
.section .rodata,"a"
.p2align 6
.amdhsa_kernel standalone__dilated_atrous__vision_kernel
  .amdhsa_next_free_vgpr 508
  .amdhsa_next_free_sgpr 102
  .amdhsa_accum_offset 252
  .amdhsa_group_segment_fixed_size 0
  .amdhsa_kernarg_size 40
  .amdhsa_user_sgpr_count 2
  .amdhsa_user_sgpr_kernarg_segment_ptr 1
  .amdhsa_system_sgpr_workgroup_id_x 1
.end_amdhsa_kernel
```
